```python
import torch

def _softmax(x, axis=-1):
    return torch.softmax(x, dim=axis)
def _gelu(x):
    return torch.nn.functional.gelu(x, approximate="tanh")
def _silu(x):
    return torch.nn.functional.silu(x)
def _sigmoid(x):
    return torch.sigmoid(x)
def _layernorm(x, axis=-1, eps=1e-5):
    m = x.mean(dim=axis, keepdim=True)
    v = x.var(dim=axis, keepdim=True, unbiased=False)
    return (x - m) / torch.sqrt(v + eps)
def _scatter_add(tgt, idx, src, axis=0):
    return tgt.clone().index_add_(axis, idx, src)
def _segment_sum(src, seg, n):
    out = torch.zeros((n,) + src.shape[1:], dtype=src.dtype)
    return out.index_add_(0, seg, src)
def _pad(x, pw):
    flat = tuple(v for pair in reversed(pw) for v in pair)
    return torch.nn.functional.pad(x, flat)

kernel_name = 'sequential_preLN__compressed_kv_cla__swiglu_ffn__decode'

def setup_inputs():

    _w = (lambda a: (lambda t: t.to(torch.bfloat16) if t.is_floating_point() else t)(torch.as_tensor(a)))
    def _A_setup():
        B, H, Sq, Sk, D, M = 4, 32, 1, 4096, 128, 512
        Dc = 4 * D
        return {
            "x": _w((lambda *s: torch.randn(*s, dtype=torch.bfloat16) * 0.05)(B, Sq, M)),
            "c_kv": _w((lambda *s: torch.randn(*s, dtype=torch.bfloat16) * 0.4)(B, Sk, Dc)),
            "w_q": _w((lambda *s: torch.randn(*s, dtype=torch.bfloat16) * 3.2)(M, H, D) * (M ** -0.5)),
            "w_uk": _w((lambda *s: torch.randn(*s, dtype=torch.bfloat16) * 3.2)(Dc, H, D) * (Dc ** -0.5)),
            "w_uv": _w((lambda *s: torch.randn(*s, dtype=torch.bfloat16) * 0.4)(Dc, H, D) * (Dc ** -0.5)),
            "w_o": _w((lambda *s: torch.randn(*s, dtype=torch.bfloat16) * 0.4)(H, D, M) * ((H * D) ** -0.5)),
        }
    _A_in = _A_setup()

    def _B_setup():
        B, S, D, F = 4, 1, 512, 1376
        return {
            "x": _w((lambda *s: torch.randn(*s, dtype=torch.bfloat16) * 0.05)(B, S, D)),
            "w_gate": _w((lambda *s: torch.randn(*s, dtype=torch.bfloat16) * 0.05)(D, F)),
            "w_up": _w((lambda *s: torch.randn(*s, dtype=torch.bfloat16) * 0.05)(D, F)),
            "w_down": _w((lambda *s: torch.randn(*s, dtype=torch.bfloat16) * 0.05)(F, D)),
        }
    _B_in = _B_setup()

    return {
        "A_x": _A_in["x"],
        "A_c_kv": _A_in["c_kv"],
        "A_w_q": _A_in["w_q"],
        "A_w_uk": _A_in["w_uk"],
        "A_w_uv": _A_in["w_uv"],
        "A_w_o": _A_in["w_o"],
        "B_x": _B_in["x"],
        "B_w_gate": _B_in["w_gate"],
        "B_w_up": _B_in["w_up"],
        "B_w_down": _B_in["w_down"],
    }

def reference(A_x, A_c_kv, A_w_q, A_w_uk, A_w_uv, A_w_o, B_x, B_w_gate, B_w_up, B_w_down):
    def _A_ref(x, c_kv, w_q, w_uk, w_uv, w_o):
        B, Sq, M = x.shape[0], x.shape[1], x.shape[2]
        Sk = c_kv.shape[1]
        H, D = w_q.shape[1], w_q.shape[2]
        q = torch.einsum("bqm,mhd->bhqd", x, w_q)
        k = torch.einsum("bkc,chd->bhkd", c_kv, w_uk)
        v = torch.einsum("bkc,chd->bhkd", c_kv, w_uv)
        scores = torch.einsum("bhqd,bhkd->bhqk", q, k) * (D ** -0.5)
        off = Sk - Sq
        qi = torch.arange(Sq)[:, None]
        kj = torch.arange(Sk)[None, :]
        cmask = kj <= (qi + off)
        scores = torch.where(cmask[None, None], scores, -1e9)
        p = _softmax(scores, axis=-1)
        ctx = torch.einsum("bhqk,bhkd->bhqd", p, v)
        return torch.einsum("bhqd,hdm->bqm", ctx, w_o)

    def _B_ref(x, w_gate, w_up, w_down):
        g = _silu(x @ w_gate)
        u = x @ w_up
        return (g * u) @ w_down

    x = A_x
    h = x + _A_ref(_layernorm(x, axis=-1), A_c_kv, A_w_q, A_w_uk, A_w_uv, A_w_o)
    h2 = h + _B_ref(_layernorm(h, axis=-1), B_w_gate, B_w_up, B_w_down)
    return h2
```

```asm
; @launch grid=(256,1,1) block=(512,1,1) lds=163840
.amdgcn_target "amdgcn-amd-amdhsa--gfx950"
.text
.globl sequential_preLN__compressed_kv_cla__swiglu_ffn__decode_kernel
.p2align 8
.type sequential_preLN__compressed_kv_cla__swiglu_ffn__decode_kernel,@function
sequential_preLN__compressed_kv_cla__swiglu_ffn__decode_kernel:
    s_load_dwordx2 s[40:41], s[0:1], 16
    s_load_dwordx2 s[32:33], s[0:1], 0
    s_load_dwordx2 s[44:45], s[0:1], 24
    s_load_dwordx2 s[36:37], s[0:1], 8
    s_load_dwordx2 s[72:73], s[0:1], 96
    s_cmp_ge_u32 s2, 256
    s_cbranch_scc1 L_end
    s_getpc_b64 s[88:89]
    v_lshlrev_b32 v9, 6, v0
    v_min_u32 v9, L_end-sequential_preLN__compressed_kv_cla__swiglu_ffn__decode_kernel-256, v9
    global_load_dword v29, v9, s[88:89]
    v_lshrrev_b32 v8, 6, v0
    v_and_b32 v1, 63, v0
    v_and_b32 v2, 15, v0
    v_readfirstlane_b32 s3, v8
    v_bfe_u32 v3, v0, 4, 2
    v_lshlrev_b32 v4, 4, v1
    v_lshlrev_b32 v12, 16, v3
    v_lshl_add_u32 v12, v2, 4, v12
    s_and_b32 s4, s2, 7
    s_lshr_b32 s7, s2, 4
    s_and_b32 s25, s7, 3
    s_lshl2_add_u32 s25, s4, s25
    s_lshr_b32 s26, s7, 2
    s_lshl_b32 s14, s25, 8
    s_and_b32 s92, s3, 3
    s_mov_b32 s42, 4194304
    s_mov_b32 s43, 0x20000
    s_mov_b32 s34, 4096
    s_mov_b32 s35, 0x20000
    s_mov_b32 s46, 4194304
    s_mov_b32 s47, 0x20000
    s_bitcmp1_b32 s2, 3
    s_cbranch_scc1 L_f0
    s_cmp_ge_u32 s3, 4
    s_cbranch_scc1 L_al0
    s_lshl_b32 s13, s3, 20
    s_add_u32 s13, s13, s14
    s_add_u32 s15, s26, 0
    s_and_b32 s15, s15, 3
    s_lshl_b32 s15, s15, 18
    s_add_u32 s16, s15, s13
    s_waitcnt lgkmcnt(0)
    s_barrier
    buffer_load_dwordx4 v[32:35], v12, s[40:43], s16 offen
    s_add_u32 s16, s16, 8192
    buffer_load_dwordx4 v[36:39], v12, s[40:43], s16 offen
    s_add_u32 s16, s16, 8192
    buffer_load_dwordx4 v[40:43], v12, s[40:43], s16 offen
    s_add_u32 s16, s16, 8192
    buffer_load_dwordx4 v[44:47], v12, s[40:43], s16 offen
    s_add_u32 s16, s16, 8192
    buffer_load_dwordx4 v[48:51], v12, s[40:43], s16 offen
    s_add_u32 s16, s16, 8192
    buffer_load_dwordx4 v[52:55], v12, s[40:43], s16 offen
    s_add_u32 s16, s16, 8192
    buffer_load_dwordx4 v[56:59], v12, s[40:43], s16 offen
    s_add_u32 s16, s16, 8192
    buffer_load_dwordx4 v[60:63], v12, s[40:43], s16 offen
    s_branch L_j1
L_al0:
    s_setprio 3
    s_lshl_b32 s15, s92, 10
    v_lshlrev_b32 v8, 2, v1
    v_add_u32 v8, 163136, v8
    v_mov_b32 v11, 0
    ds_write_b32 v8, v11
    v_lshlrev_b32 v8, 3, v2
    v_add_u32 v8, 152640, v8
    v_mov_b32 v10, 0xff800000
    ds_write2_b32 v8, v10, v11 offset0:0 offset1:1
    s_waitcnt lgkmcnt(0)
    buffer_load_dwordx4 v[32:35], v4, s[32:35], s15 offen
    s_branch L_j0
L_f0:
    s_cmp_ge_u32 s3, 4
    s_cbranch_scc1 L_f1
    v_lshrrev_b32 v10, 1, v1
    v_lshlrev_b32 v10, 13, v10
    v_and_b32 v11, 1, v1
    v_lshl_add_u32 v10, v11, 7, v10
    s_lshl2_add_u32 s19, s26, s3
    s_lshl_b32 s19, s19, 18
    s_add_u32 s19, s19, s14
    s_waitcnt lgkmcnt(0)
    buffer_load_dword v30, v10, s[44:47], s19 offen
    s_branch L_j0
L_f1:
    v_lshlrev_b32 v8, 2, v1
    v_add_u32 v8, 163136, v8
    v_mov_b32 v11, 0
    ds_write_b32 v8, v11
    v_lshlrev_b32 v8, 3, v2
    v_add_u32 v8, 152640, v8
    v_mov_b32 v10, 0xff800000
    ds_write2_b32 v8, v10, v11 offset0:0 offset1:1
    s_waitcnt lgkmcnt(0)
L_j0:
    s_barrier
L_j1:
    s_load_dword s12, s[72:73], 0
    s_load_dwordx2 s[48:49], s[0:1], 32
    s_load_dwordx2 s[52:53], s[0:1], 40
    s_load_dwordx2 s[56:57], s[0:1], 56
    s_load_dwordx2 s[60:61], s[0:1], 64
    s_load_dwordx2 s[64:65], s[0:1], 72
    s_load_dwordx2 s[68:69], s[0:1], 80
    v_mov_b32 v5, 163136
    v_mov_b32 v6, 1
    s_mov_b32 s38, 16777216
    s_mov_b32 s39, 0x20000
    s_mov_b32 s74, 17825792
    s_mov_b32 s75, 0x20000
    s_mov_b32 s50, 4194304
    s_mov_b32 s51, 0x20000
    s_mov_b32 s54, 4194304
    s_mov_b32 s55, 0x20000
    s_mov_b32 s58, 1409024
    s_mov_b32 s59, 0x20000
    s_mov_b32 s62, 1409024
    s_mov_b32 s63, 0x20000
    s_mov_b32 s66, 1409024
    s_mov_b32 s67, 0x20000
    s_mov_b32 s70, 4096
    s_mov_b32 s71, 0x20000
    s_mov_b32 s78, 11008
    s_mov_b32 s79, 0x20000
    s_lshr_b32 s5, s2, 3
    s_and_b32 s17, s5, 1
    s_xor_b32 s10, s17, 1
    s_lshl_b32 s6, s17, 4
    s_lshl1_add_u32 s6, s4, s6
    s_and_b32 s18, s7, 1
    s_add_u32 s6, s6, s18
    s_bfe_u32 s8, s5, 0x20002
    s_lshr_b32 s9, s5, 4
    s_lshl4_add_u32 s11, s4, s7
    s_mov_b32 s80, 0x05040100
    s_mov_b32 s81, 0x07060302
    s_mov_b32 s84, 0x000f000f
    s_mov_b32 s85, 0x000f000f
    s_mov_b32 s82, 0x00ff00ff
    s_mov_b32 s83, 0x00ff00ff
    s_mul_i32 s27, s4, 11
    s_add_u32 s27, s27, s7
    s_cmp_lt_u32 s7, 11
    s_cselect_b32 s29, s17, 0
    s_cmp_lt_u32 s27, 86
    s_cselect_b32 s29, s29, 0
    s_cmp_ge_u32 s7, 12
    s_cselect_b32 s30, s10, 0
    s_sub_u32 s28, s7, 12
    s_lshl3_add_u32 s28, s28, s4
    s_cmp_ge_u32 s3, 6
    s_cbranch_scc1 L_wave67
    s_cmp_ge_u32 s3, 4
    s_cbranch_scc1 L_wave45
    s_setprio 2
    s_cmp_eq_u32 s10, 0
    s_cbranch_scc1 L_freeC
    s_lshl_b32 s17, s3, 5
    s_lshl_b32 s18, s26, 7
    s_add_u32 s17, s17, s18
    s_lshl_b32 s17, s17, 13
    s_add_u32 s17, s17, s14
    s_add_u32 s18, s17, 131072
    v_lshlrev_b32 v13, 13, v2
    v_lshl_add_u32 v13, v3, 4, v13
    v_and_b32 v9, 3, v2
    v_mul_u32_u24 v8, 1040, v9
    v_lshl_add_u32 v8, v3, 4, v8
    s_lshl_b32 s19, s3, 8
    s_add_u32 s19, s19, 147456
    v_add_u32 v8, s19, v8
    s_lshl_b32 s19, s3, 11
    s_add_u32 s19, s19, 153152
    v_lshlrev_b32 v14, 6, v3
    v_lshl_add_u32 v17, v9, 4, v14
    v_add_u32 v14, s19, v17
    v_add_u32 v17, 151616, v17
    s_lshl_b32 s19, s3, 9
    s_add_u32 s19, s19, 153152
    v_lshlrev_b32 v15, 2, v1
    v_add_u32 v15, s19, v15
    v_lshlrev_b32 v16, 6, v9
    v_and_b32 v10, 12, v1
    v_lshl_add_u32 v16, v10, 2, v16
    v_lshl_add_u32 v16, v3, 8, v16
    s_lshl_b32 s19, s3, 2
    s_add_u32 s19, s19, 151616
    v_add_u32 v16, s19, v16
    v_lshlrev_b32 v18, 16, v9
    v_lshl_add_u32 v18, v3, 4, v18
    v_bfe_u32 v10, v2, 2, 1
    v_lshl_add_u32 v18, v10, 6, v18
    v_cmp_eq_u32 s[88:89], 1, v10
    s_lshl_b32 s19, s25, 11
    s_lshl_b32 s20, s26, 9
    s_add_u32 s19, s19, s20
    s_lshl_b32 s20, s3, 7
    s_add_u32 s19, s19, s20
    s_add_u32 s19, s19, 65536
    s_mov_b32 s20, 0x3e0293ee
    s_add_u32 s15, s26, 0
    s_and_b32 s15, s15, 3
    s_lshl_b32 s15, s15, 6
    v_add_u32 v19, s15, v8
    s_add_u32 s15, s26, 1
    s_and_b32 s15, s15, 3
    s_lshl_b32 s15, s15, 6
    v_add_u32 v20, s15, v8
    s_add_u32 s15, s26, 2
    s_and_b32 s15, s15, 3
    s_lshl_b32 s15, s15, 6
    v_add_u32 v21, s15, v8
    s_add_u32 s15, s26, 3
    s_and_b32 s15, s15, 3
    s_lshl_b32 s15, s15, 6
    v_add_u32 v22, s15, v8
    s_add_u32 s15, s26, 1
    s_and_b32 s15, s15, 3
    s_lshl_b32 s15, s15, 18
    s_add_u32 s16, s15, s13
    buffer_load_dwordx4 v[64:67], v12, s[40:43], s16 offen
    s_add_u32 s16, s16, 8192
    buffer_load_dwordx4 v[68:71], v12, s[40:43], s16 offen
    s_add_u32 s16, s16, 8192
    buffer_load_dwordx4 v[72:75], v12, s[40:43], s16 offen
    s_add_u32 s16, s16, 8192
    buffer_load_dwordx4 v[76:79], v12, s[40:43], s16 offen
    s_add_u32 s16, s16, 8192
    buffer_load_dwordx4 v[80:83], v12, s[40:43], s16 offen
    s_add_u32 s16, s16, 8192
    buffer_load_dwordx4 v[84:87], v12, s[40:43], s16 offen
    s_add_u32 s16, s16, 8192
    buffer_load_dwordx4 v[88:91], v12, s[40:43], s16 offen
    s_add_u32 s16, s16, 8192
    buffer_load_dwordx4 v[92:95], v12, s[40:43], s16 offen
    s_add_u32 s15, s26, 2
    s_and_b32 s15, s15, 3
    s_lshl_b32 s15, s15, 18
    s_add_u32 s16, s15, s13
    buffer_load_dwordx4 v[96:99], v12, s[40:43], s16 offen
    s_add_u32 s16, s16, 8192
    buffer_load_dwordx4 v[100:103], v12, s[40:43], s16 offen
    s_add_u32 s16, s16, 8192
    buffer_load_dwordx4 v[104:107], v12, s[40:43], s16 offen
    s_add_u32 s16, s16, 8192
    buffer_load_dwordx4 v[108:111], v12, s[40:43], s16 offen
    s_add_u32 s16, s16, 8192
    buffer_load_dwordx4 v[112:115], v12, s[40:43], s16 offen
    s_add_u32 s16, s16, 8192
    buffer_load_dwordx4 v[116:119], v12, s[40:43], s16 offen
    s_add_u32 s16, s16, 8192
    buffer_load_dwordx4 v[120:123], v12, s[40:43], s16 offen
    s_add_u32 s16, s16, 8192
    buffer_load_dwordx4 v[124:127], v12, s[40:43], s16 offen
    s_mov_b32 s31, 0
Lw_1:
    ds_read_b32 v31, v5 offset:0
    ds_read_b128 v[224:227], v19
    ds_read_b128 v[228:231], v20
    ds_read_b128 v[232:235], v21
    ds_read_b128 v[236:239], v22
    s_waitcnt lgkmcnt(0)
    v_readfirstlane_b32 s86, v31
    s_nop 0
    s_cmp_ge_u32 s86, 4
    s_nop 2
    s_cbranch_scc1 Lwd_2
    s_add_u32 s31, s31, 1
    s_cmp_lt_u32 s31, 1048576
    s_cbranch_scc1 Lw_1
Lwd_2:
    s_add_u32 s12, s12, 1
    s_waitcnt vmcnt(16)
    s_add_u32 s15, s26, 3
    s_and_b32 s15, s15, 3
    s_lshl_b32 s15, s15, 18
    s_add_u32 s16, s15, s13
    buffer_load_dwordx4 v[128:131], v12, s[40:43], s16 offen
    v_perm_b32 v160, v36, v32, s80
    v_perm_b32 v161, v44, v40, s80
    v_perm_b32 v162, v52, v48, s80
    v_perm_b32 v163, v60, v56, s80
    s_add_u32 s16, s16, 8192
    buffer_load_dwordx4 v[132:135], v12, s[40:43], s16 offen
    v_perm_b32 v164, v36, v32, s81
    v_perm_b32 v165, v44, v40, s81
    v_perm_b32 v166, v52, v48, s81
    v_perm_b32 v167, v60, v56, s81
    v_mfma_f32_16x16x32_bf16 v[192:195], v[160:163], v[224:227], 0
    s_add_u32 s16, s16, 8192
    buffer_load_dwordx4 v[136:139], v12, s[40:43], s16 offen
    v_perm_b32 v168, v37, v33, s80
    v_perm_b32 v169, v45, v41, s80
    v_perm_b32 v170, v53, v49, s80
    v_perm_b32 v171, v61, v57, s80
    v_mfma_f32_16x16x32_bf16 v[196:199], v[164:167], v[224:227], 0
    s_add_u32 s16, s16, 8192
    buffer_load_dwordx4 v[140:143], v12, s[40:43], s16 offen
    v_perm_b32 v172, v37, v33, s81
    v_perm_b32 v173, v45, v41, s81
    v_perm_b32 v174, v53, v49, s81
    v_perm_b32 v175, v61, v57, s81
    v_mfma_f32_16x16x32_bf16 v[200:203], v[168:171], v[224:227], 0
    s_add_u32 s16, s16, 8192
    buffer_load_dwordx4 v[144:147], v12, s[40:43], s16 offen
    v_perm_b32 v176, v38, v34, s80
    v_perm_b32 v177, v46, v42, s80
    v_perm_b32 v178, v54, v50, s80
    v_perm_b32 v179, v62, v58, s80
    v_mfma_f32_16x16x32_bf16 v[204:207], v[172:175], v[224:227], 0
    s_add_u32 s16, s16, 8192
    buffer_load_dwordx4 v[148:151], v12, s[40:43], s16 offen
    v_perm_b32 v180, v38, v34, s81
    v_perm_b32 v181, v46, v42, s81
    v_perm_b32 v182, v54, v50, s81
    v_perm_b32 v183, v62, v58, s81
    v_mfma_f32_16x16x32_bf16 v[208:211], v[176:179], v[224:227], 0
    s_add_u32 s16, s16, 8192
    buffer_load_dwordx4 v[152:155], v12, s[40:43], s16 offen
    v_perm_b32 v184, v39, v35, s80
    v_perm_b32 v185, v47, v43, s80
    v_perm_b32 v186, v55, v51, s80
    v_perm_b32 v187, v63, v59, s80
    v_mfma_f32_16x16x32_bf16 v[212:215], v[180:183], v[224:227], 0
    s_add_u32 s16, s16, 8192
    buffer_load_dwordx4 v[156:159], v12, s[40:43], s16 offen
    v_perm_b32 v188, v39, v35, s81
    v_perm_b32 v189, v47, v43, s81
    v_perm_b32 v190, v55, v51, s81
    v_perm_b32 v191, v63, v59, s81
    v_mfma_f32_16x16x32_bf16 v[216:219], v[184:187], v[224:227], 0
    s_nop 0
    v_mfma_f32_16x16x32_bf16 v[220:223], v[188:191], v[224:227], 0
    s_waitcnt vmcnt(16)
    buffer_load_dwordx4 v[32:35], v13, s[44:47], s17 offen offset:0
    v_perm_b32 v160, v68, v64, s80
    v_perm_b32 v161, v76, v72, s80
    v_perm_b32 v162, v84, v80, s80
    v_perm_b32 v163, v92, v88, s80
    buffer_load_dwordx4 v[36:39], v13, s[44:47], s17 offen offset:64
    v_perm_b32 v164, v68, v64, s81
    v_perm_b32 v165, v76, v72, s81
    v_perm_b32 v166, v84, v80, s81
    v_perm_b32 v167, v92, v88, s81
    v_mfma_f32_16x16x32_bf16 v[192:195], v[160:163], v[228:231], v[192:195]
    buffer_load_dwordx4 v[40:43], v13, s[44:47], s17 offen offset:128
    v_perm_b32 v168, v69, v65, s80
    v_perm_b32 v169, v77, v73, s80
    v_perm_b32 v170, v85, v81, s80
    v_perm_b32 v171, v93, v89, s80
    v_mfma_f32_16x16x32_bf16 v[196:199], v[164:167], v[228:231], v[196:199]
    buffer_load_dwordx4 v[44:47], v13, s[44:47], s17 offen offset:192
    v_perm_b32 v172, v69, v65, s81
    v_perm_b32 v173, v77, v73, s81
    v_perm_b32 v174, v85, v81, s81
    v_perm_b32 v175, v93, v89, s81
    v_mfma_f32_16x16x32_bf16 v[200:203], v[168:171], v[228:231], v[200:203]
    buffer_load_dwordx4 v[48:51], v13, s[44:47], s18 offen offset:0
    v_perm_b32 v176, v70, v66, s80
    v_perm_b32 v177, v78, v74, s80
    v_perm_b32 v178, v86, v82, s80
    v_perm_b32 v179, v94, v90, s80
    v_mfma_f32_16x16x32_bf16 v[204:207], v[172:175], v[228:231], v[204:207]
    buffer_load_dwordx4 v[52:55], v13, s[44:47], s18 offen offset:64
    v_perm_b32 v180, v70, v66, s81
    v_perm_b32 v181, v78, v74, s81
    v_perm_b32 v182, v86, v82, s81
    v_perm_b32 v183, v94, v90, s81
    v_mfma_f32_16x16x32_bf16 v[208:211], v[176:179], v[228:231], v[208:211]
    buffer_load_dwordx4 v[56:59], v13, s[44:47], s18 offen offset:128
    v_perm_b32 v184, v71, v67, s80
    v_perm_b32 v185, v79, v75, s80
    v_perm_b32 v186, v87, v83, s80
    v_perm_b32 v187, v95, v91, s80
    v_mfma_f32_16x16x32_bf16 v[212:215], v[180:183], v[228:231], v[212:215]
    buffer_load_dwordx4 v[60:63], v13, s[44:47], s18 offen offset:192
    v_perm_b32 v188, v71, v67, s81
    v_perm_b32 v189, v79, v75, s81
    v_perm_b32 v190, v87, v83, s81
    v_perm_b32 v191, v95, v91, s81
    v_mfma_f32_16x16x32_bf16 v[216:219], v[184:187], v[228:231], v[216:219]
    s_nop 0
    v_mfma_f32_16x16x32_bf16 v[220:223], v[188:191], v[228:231], v[220:223]
    s_mov_b64 exec, 1
    ds_add_u32 v5, v6 offset:28
    s_mov_b64 exec, -1
    s_waitcnt vmcnt(16)
    v_perm_b32 v160, v100, v96, s80
    v_perm_b32 v161, v108, v104, s80
    v_perm_b32 v162, v116, v112, s80
    v_perm_b32 v163, v124, v120, s80
    v_perm_b32 v164, v100, v96, s81
    v_perm_b32 v165, v108, v104, s81
    v_perm_b32 v166, v116, v112, s81
    v_perm_b32 v167, v124, v120, s81
    v_mfma_f32_16x16x32_bf16 v[192:195], v[160:163], v[232:235], v[192:195]
    v_perm_b32 v168, v101, v97, s80
    v_perm_b32 v169, v109, v105, s80
    v_perm_b32 v170, v117, v113, s80
    v_perm_b32 v171, v125, v121, s80
    v_mfma_f32_16x16x32_bf16 v[196:199], v[164:167], v[232:235], v[196:199]
    v_perm_b32 v172, v101, v97, s81
    v_perm_b32 v173, v109, v105, s81
    v_perm_b32 v174, v117, v113, s81
    v_perm_b32 v175, v125, v121, s81
    v_mfma_f32_16x16x32_bf16 v[200:203], v[168:171], v[232:235], v[200:203]
    v_perm_b32 v176, v102, v98, s80
    v_perm_b32 v177, v110, v106, s80
    v_perm_b32 v178, v118, v114, s80
    v_perm_b32 v179, v126, v122, s80
    v_mfma_f32_16x16x32_bf16 v[204:207], v[172:175], v[232:235], v[204:207]
    v_perm_b32 v180, v102, v98, s81
    v_perm_b32 v181, v110, v106, s81
    v_perm_b32 v182, v118, v114, s81
    v_perm_b32 v183, v126, v122, s81
    v_mfma_f32_16x16x32_bf16 v[208:211], v[176:179], v[232:235], v[208:211]
    v_perm_b32 v184, v103, v99, s80
    v_perm_b32 v185, v111, v107, s80
    v_perm_b32 v186, v119, v115, s80
    v_perm_b32 v187, v127, v123, s80
    v_mfma_f32_16x16x32_bf16 v[212:215], v[180:183], v[232:235], v[212:215]
    v_perm_b32 v188, v103, v99, s81
    v_perm_b32 v189, v111, v107, s81
    v_perm_b32 v190, v119, v115, s81
    v_perm_b32 v191, v127, v123, s81
    v_mfma_f32_16x16x32_bf16 v[216:219], v[184:187], v[232:235], v[216:219]
    s_nop 0
    v_mfma_f32_16x16x32_bf16 v[220:223], v[188:191], v[232:235], v[220:223]
    s_waitcnt vmcnt(8)
    v_perm_b32 v160, v132, v128, s80
    v_perm_b32 v161, v140, v136, s80
    v_perm_b32 v162, v148, v144, s80
    v_perm_b32 v163, v156, v152, s80
    v_perm_b32 v164, v132, v128, s81
    v_perm_b32 v165, v140, v136, s81
    v_perm_b32 v166, v148, v144, s81
    v_perm_b32 v167, v156, v152, s81
    v_mfma_f32_16x16x32_bf16 v[192:195], v[160:163], v[236:239], v[192:195]
    v_perm_b32 v168, v133, v129, s80
    v_perm_b32 v169, v141, v137, s80
    v_perm_b32 v170, v149, v145, s80
    v_perm_b32 v171, v157, v153, s80
    v_mfma_f32_16x16x32_bf16 v[196:199], v[164:167], v[236:239], v[196:199]
    v_perm_b32 v172, v133, v129, s81
    v_perm_b32 v173, v141, v137, s81
    v_perm_b32 v174, v149, v145, s81
    v_perm_b32 v175, v157, v153, s81
    v_mfma_f32_16x16x32_bf16 v[200:203], v[168:171], v[236:239], v[200:203]
    v_perm_b32 v176, v134, v130, s80
    v_perm_b32 v177, v142, v138, s80
    v_perm_b32 v178, v150, v146, s80
    v_perm_b32 v179, v158, v154, s80
    v_mfma_f32_16x16x32_bf16 v[204:207], v[172:175], v[236:239], v[204:207]
    v_perm_b32 v180, v134, v130, s81
    v_perm_b32 v181, v142, v138, s81
    v_perm_b32 v182, v150, v146, s81
    v_perm_b32 v183, v158, v154, s81
    v_mfma_f32_16x16x32_bf16 v[208:211], v[176:179], v[236:239], v[208:211]
    v_perm_b32 v184, v135, v131, s80
    v_perm_b32 v185, v143, v139, s80
    v_perm_b32 v186, v151, v147, s80
    v_perm_b32 v187, v159, v155, s80
    v_mfma_f32_16x16x32_bf16 v[212:215], v[180:183], v[236:239], v[212:215]
    v_perm_b32 v188, v135, v131, s81
    v_perm_b32 v189, v143, v139, s81
    v_perm_b32 v190, v151, v147, s81
    v_perm_b32 v191, v159, v155, s81
    v_mfma_f32_16x16x32_bf16 v[216:219], v[184:187], v[236:239], v[216:219]
    s_nop 0
    v_mfma_f32_16x16x32_bf16 v[220:223], v[188:191], v[236:239], v[220:223]
    s_mov_b64 exec, s[84:85]
    ds_write_b128 v14, v[192:195] offset:0
    ds_write_b128 v14, v[196:199] offset:256
    ds_write_b128 v14, v[200:203] offset:512
    ds_write_b128 v14, v[204:207] offset:768
    ds_write_b128 v14, v[208:211] offset:1024
    ds_write_b128 v14, v[212:215] offset:1280
    ds_write_b128 v14, v[216:219] offset:1536
    ds_write_b128 v14, v[220:223] offset:1792
    s_mov_b64 exec, 1
    ds_add_u32 v5, v6 offset:8
    s_mov_b64 exec, -1
    s_mov_b32 s31, 0
Lw_3:
    ds_read_b32 v31, v5 offset:8
    ds_read2st64_b32 v[160:161], v15 offset0:0 offset1:1
    ds_read2st64_b32 v[162:163], v15 offset0:8 offset1:9
    ds_read2st64_b32 v[164:165], v15 offset0:16 offset1:17
    ds_read2st64_b32 v[166:167], v15 offset0:24 offset1:25
    s_waitcnt lgkmcnt(0)
    v_readfirstlane_b32 s86, v31
    s_nop 0
    s_cmp_ge_u32 s86, 4
    s_nop 2
    s_cbranch_scc1 Lwd_4
    s_add_u32 s31, s31, 1
    s_cmp_lt_u32 s31, 1048576
    s_cbranch_scc1 Lw_3
Lwd_4:
    v_add_f32 v160, v160, v162
    v_add_f32 v161, v161, v163
    v_add_f32 v164, v164, v166
    v_add_f32 v165, v165, v167
    v_add_f32 v160, v160, v164
    v_add_f32 v161, v161, v165
    v_cvt_pk_bf16_f32 v160, v160, v161
    ds_write_b32 v16, v160
    s_mov_b64 exec, 1
    ds_add_u32 v5, v6 offset:12
    s_mov_b64 exec, -1
    v_mov_b32 v201, s12
    v_mov_b32 v203, s12
    s_mov_b32 s31, 0
    s_nop 0
Lw_5:
    ds_read_b32 v31, v5 offset:12
    ds_read_b32 v11, v5 offset:4
    ds_read_b128 v[168:171], v17 offset:0
    ds_read_b128 v[172:175], v17 offset:256
    ds_read_b128 v[176:179], v17 offset:512
    ds_read_b128 v[180:183], v17 offset:768
    s_waitcnt lgkmcnt(0)
    v_readfirstlane_b32 s86, v31
    s_nop 0
    s_cmp_ge_u32 s86, 4
    s_nop 2
    s_cbranch_scc1 Lwd_6
    s_add_u32 s31, s31, 1
    s_cmp_lt_u32 s31, 1048576
    s_cbranch_scc1 Lw_5
Lwd_6:
    s_waitcnt vmcnt(0)
    v_mfma_f32_16x16x32_bf16 v[192:195], v[32:35], v[168:171], 0
    v_mfma_f32_16x16x32_bf16 v[196:199], v[48:51], v[168:171], 0
    v_mfma_f32_16x16x32_bf16 v[192:195], v[36:39], v[172:175], v[192:195]
    v_mfma_f32_16x16x32_bf16 v[196:199], v[52:55], v[172:175], v[196:199]
    v_mfma_f32_16x16x32_bf16 v[192:195], v[40:43], v[176:179], v[192:195]
    v_mfma_f32_16x16x32_bf16 v[196:199], v[56:59], v[176:179], v[196:199]
    v_mfma_f32_16x16x32_bf16 v[192:195], v[44:47], v[180:183], v[192:195]
    v_mfma_f32_16x16x32_bf16 v[196:199], v[60:63], v[180:183], v[196:199]
    v_readfirstlane_b32 s86, v11
    s_nop 0
    s_cmp_ge_u32 s86, 2
    s_nop 4
    s_cbranch_scc1 L_clrok
    s_mov_b32 s31, 0
Lw_7:
    ds_read_b32 v31, v5 offset:4
    s_waitcnt lgkmcnt(0)
    v_readfirstlane_b32 s86, v31
    s_nop 0
    s_cmp_ge_u32 s86, 2
    s_nop 2
    s_cbranch_scc1 Lwd_8
    s_add_u32 s31, s31, 1
    s_cmp_lt_u32 s31, 1048576
    s_cbranch_scc1 Lw_7
Lwd_8:
L_clrok:
    v_cndmask_b32 v192, v192, v196, s[88:89]
    v_cndmask_b32 v193, v193, v197, s[88:89]
    v_cndmask_b32 v194, v194, v198, s[88:89]
    v_cndmask_b32 v195, v195, v199, s[88:89]
    v_mul_f32 v192, s20, v192
    v_mul_f32 v193, s20, v193
    v_mul_f32 v194, s20, v194
    v_mul_f32 v195, s20, v195
    v_cvt_pk_bf16_f32 v200, v192, v193
    v_cvt_pk_bf16_f32 v202, v194, v195
    s_mov_b64 exec, s[82:83]
    buffer_store_dwordx4 v[200:203], v18, s[72:75], s19 offen sc1
    s_mov_b64 exec, -1
    s_nop 0
    s_branch L_phaseB
L_freeC:
    s_waitcnt vmcnt(0)
    s_mov_b64 exec, 1
    ds_add_u32 v5, v6 offset:28
    s_mov_b64 exec, -1
    s_mov_b32 s31, 0
Lw_9:
    ds_read_b32 v31, v5 offset:4
    s_waitcnt lgkmcnt(0)
    v_readfirstlane_b32 s86, v31
    s_nop 0
    s_cmp_ge_u32 s86, 2
    s_nop 2
    s_cbranch_scc1 Lwd_10
    s_sleep 4
    s_add_u32 s31, s31, 1
    s_cmp_lt_u32 s31, 1048576
    s_cbranch_scc1 Lw_9
Lwd_10:
    s_add_u32 s12, s12, 1
L_phaseB:
    v_lshrrev_b32 v8, 3, v2
    v_lshlrev_b32 v9, 2, v8
    v_and_b32 v10, 7, v2
    v_xor_b32 v10, v10, v9
    v_lshl_add_u32 v10, v10, 1, v8
    v_xor_b32 v10, v10, v3
    v_lshlrev_b32 v10, 4, v10
    v_lshl_add_u32 v10, v2, 10, v10
    s_lshl_b32 s13, s3, 15
    v_add_u32 v23, s13, v10
    v_add_u32 v12, 131072, v10
    v_xor_b32 v24, 64, v23
    v_xor_b32 v13, 64, v12
    v_xor_b32 v25, 128, v23
    v_xor_b32 v14, 128, v12
    v_xor_b32 v26, 192, v23
    v_xor_b32 v15, 192, v12
    s_lshl_b32 s14, s3, 3
    v_add_u32 v20, s14, v5
    v_bfe_u32 v8, v1, 2, 4
    v_lshrrev_b32 v9, 3, v8
    v_lshlrev_b32 v10, 2, v9
    v_and_b32 v11, 7, v8
    v_xor_b32 v11, v11, v10
    v_lshl_add_u32 v11, v11, 1, v9
    v_bfe_u32 v9, v1, 1, 1
    v_xor_b32 v11, v11, v9
    v_lshlrev_b32 v11, 4, v11
    v_and_b32 v9, 1, v1
    v_lshl_add_u32 v11, v9, 3, v11
    v_lshl_add_u32 v11, v8, 10, v11
    s_lshl_b32 s13, s3, 8
    v_add_u32 v21, s13, v11
    v_and_b32 v8, 1, v3
    v_lshlrev_b32 v8, 5, v8
    v_lshrrev_b32 v9, 1, v3
    v_lshl_add_u32 v8, v9, 4, v8
    v_and_b32 v9, 7, v2
    v_lshl_add_u32 v22, v9, 17, v8
    v_lshrrev_b32 v9, 3, v2
    v_lshl_add_u32 v22, v9, 6, v22
    s_lshl_b32 s24, s10, 21
    s_lshl_b32 s17, s11, 8
    s_add_u32 s24, s24, s17
    s_lshl_b32 s17, s3, 15
    s_add_u32 s24, s24, s17
    s_add_u32 s24, s24, 2097152
    s_add_u32 s16, s24, 1048576
    v_lshlrev_b32 v16, 3, v2
    v_add_u32 v16, 152640, v16
    s_lshl_b32 s13, s3, 10
    s_add_u32 s13, s13, 153152
    v_add_u32 v17, s13, v4
    v_add_u32 v18, 153152, v4
    v_xor_b32 v240, 0, v21
    v_add_u32 v248, 0x10000, v240
    v_xor_b32 v241, 32, v21
    v_add_u32 v249, 0x10000, v241
    v_xor_b32 v242, 64, v21
    v_add_u32 v250, 0x10000, v242
    v_xor_b32 v243, 96, v21
    v_add_u32 v251, 0x10000, v243
    v_xor_b32 v244, 128, v21
    v_add_u32 v252, 0x10000, v244
    v_xor_b32 v245, 160, v21
    v_add_u32 v253, 0x10000, v245
    v_xor_b32 v246, 192, v21
    v_add_u32 v254, 0x10000, v246
    v_xor_b32 v247, 224, v21
    v_add_u32 v255, 0x10000, v247
    v_lshlrev_b32 v236, 4, v0
    v_add_u32 v237, 16384, v236
    s_lshr_b32 s19, s11, 5
    s_lshl_b32 s19, s19, 1
    s_add_u32 s19, s19, s10
    s_lshl_b32 s19, s19, 15
    s_add_u32 s19, s19, 65536
    s_add_u32 s20, s19, 4096
    s_add_u32 s21, s19, 8192
    s_add_u32 s22, s19, 12288
    v_and_b32 v238, 127, v0
    v_lshlrev_b32 v238, 3, v238
    s_lshr_b32 s23, s3, 1
    s_lshl_b32 s18, s23, 5
    v_xor_b32 v238, s18, v238
    s_lshl_b32 s23, s23, 10
    s_add_u32 s23, s23, 131072
    v_add_u32 v238, s23, v238
    v_mov_b32 v239, s12
    s_mov_b32 s15, 0
    s_cmp_eq_u32 s10, 1
    s_cbranch_scc1 L_not0
    s_mov_b32 s31, 0
Lw_11:
    ds_read_b32 v31, v20 offset:32
    s_waitcnt lgkmcnt(0)
    v_readfirstlane_b32 s86, v31
    s_nop 0
    s_cmp_ge_u32 s86, 1
    s_nop 2
    s_cbranch_scc1 Lwd_12
    s_sleep 1
    s_add_u32 s31, s31, 1
    s_cmp_lt_u32 s31, 1048576
    s_cbranch_scc1 Lw_11
Lwd_12:
    ds_read_b128 v[96:99], v23 offset:0
    ds_read_b128 v[100:103], v24 offset:0
    ds_read_b128 v[104:107], v25 offset:0
    ds_read_b128 v[108:111], v26 offset:0
    ds_read_b128 v[112:115], v23 offset:256
    ds_read_b128 v[116:119], v24 offset:256
    ds_read_b128 v[120:123], v25 offset:256
    ds_read_b128 v[124:127], v26 offset:256
    ds_read_b128 v[128:131], v23 offset:512
    ds_read_b128 v[132:135], v24 offset:512
    ds_read_b128 v[136:139], v25 offset:512
    ds_read_b128 v[140:143], v26 offset:512
    ds_read_b128 v[144:147], v23 offset:768
    ds_read_b128 v[148:151], v24 offset:768
    ds_read_b128 v[152:155], v25 offset:768
    ds_read_b128 v[156:159], v26 offset:768
L_not0:
    s_waitcnt vmcnt(0)
    s_mov_b32 s31, 0
Lw_13:
    ds_read_b32 v31, v5 offset:24
    s_waitcnt lgkmcnt(0)
    v_readfirstlane_b32 s86, v31
    s_nop 0
    s_cmp_ge_u32 s86, 2
    s_nop 2
    s_cbranch_scc1 Lwd_14
    s_sleep 1
    s_add_u32 s31, s31, 1
    s_cmp_lt_u32 s31, 1048576
    s_cbranch_scc1 Lw_13
Lwd_14:
    buffer_load_dwordx4 v[64:67], v236, s[72:75], s19 offen sc1
    buffer_load_dwordx4 v[68:71], v236, s[72:75], s20 offen sc1
    buffer_load_dwordx4 v[72:75], v236, s[72:75], s21 offen sc1
    buffer_load_dwordx4 v[76:79], v236, s[72:75], s22 offen sc1
    buffer_load_dwordx4 v[80:83], v237, s[72:75], s19 offen sc1
    buffer_load_dwordx4 v[84:87], v237, s[72:75], s20 offen sc1
    buffer_load_dwordx4 v[88:91], v237, s[72:75], s21 offen sc1
    buffer_load_dwordx4 v[92:95], v237, s[72:75], s22 offen sc1
    s_mov_b64 exec, 1
    ds_add_u32 v5, v6 offset:84
    s_mov_b64 exec, -1
    s_cmp_eq_u32 s10, 0
    s_cbranch_scc1 L_t0d
    s_mov_b32 s31, 0
Lw_15:
    ds_read_b32 v31, v20 offset:32
    s_waitcnt lgkmcnt(0)
    v_readfirstlane_b32 s86, v31
    s_nop 0
    s_cmp_ge_u32 s86, 1
    s_nop 2
    s_cbranch_scc1 Lwd_16
    s_add_u32 s31, s31, 1
    s_cmp_lt_u32 s31, 1048576
    s_cbranch_scc1 Lw_15
Lwd_16:
    ds_read_b128 v[96:99], v23 offset:0
    ds_read_b128 v[100:103], v24 offset:0
    ds_read_b128 v[104:107], v25 offset:0
    ds_read_b128 v[108:111], v26 offset:0
    ds_read_b128 v[112:115], v23 offset:256
    ds_read_b128 v[116:119], v24 offset:256
    ds_read_b128 v[120:123], v25 offset:256
    ds_read_b128 v[124:127], v26 offset:256
    ds_read_b128 v[128:131], v23 offset:512
    ds_read_b128 v[132:135], v24 offset:512
    ds_read_b128 v[136:139], v25 offset:512
    ds_read_b128 v[140:143], v26 offset:512
    ds_read_b128 v[144:147], v23 offset:768
    ds_read_b128 v[148:151], v24 offset:768
    ds_read_b128 v[152:155], v25 offset:768
    ds_read_b128 v[156:159], v26 offset:768
L_t0d:
    s_mov_b32 s31, 0
Lw_17:
    ds_read_b32 v31, v20 offset:36
    s_waitcnt lgkmcnt(0)
    v_readfirstlane_b32 s86, v31
    s_nop 0
    s_cmp_ge_u32 s86, 1
    s_nop 2
    s_cbranch_scc1 Lwd_18
    s_add_u32 s31, s31, 1
    s_cmp_lt_u32 s31, 1048576
    s_cbranch_scc1 Lw_17
Lwd_18:
    ds_read_b128 v[160:163], v23 offset:16384
    ds_read_b128 v[164:167], v24 offset:16384
    ds_read_b128 v[168:171], v25 offset:16384
    ds_read_b128 v[172:175], v26 offset:16384
    ds_read_b128 v[176:179], v23 offset:16640
    ds_read_b128 v[180:183], v24 offset:16640
    ds_read_b128 v[184:187], v25 offset:16640
    ds_read_b128 v[188:191], v26 offset:16640
    ds_read_b128 v[192:195], v23 offset:16896
    ds_read_b128 v[196:199], v24 offset:16896
    ds_read_b128 v[200:203], v25 offset:16896
    ds_read_b128 v[204:207], v26 offset:16896
    ds_read_b128 v[208:211], v23 offset:17152
    ds_read_b128 v[212:215], v24 offset:17152
    ds_read_b128 v[216:219], v25 offset:17152
    ds_read_b128 v[220:223], v26 offset:17152
    s_mov_b32 s23, 0
    s_waitcnt vmcnt(7)
    v_xor_b32 v10, v65, v239
    v_bitop3_b32 v10, v10, v67, v239 bitop3:0xf6
    ds_write2_b32 v238, v64, v66 offset0:0 offset1:1
    v_cmp_ne_u32 vcc, 0, v10
    s_nop 0
    s_cmp_lg_u64 vcc, 0
    s_addc_u32 s23, s23, s23
    s_waitcnt vmcnt(6)
    v_xor_b32 v10, v69, v239
    v_xor_b32 v11, 2112, v238
    v_bitop3_b32 v10, v10, v71, v239 bitop3:0xf6
    ds_write2_b32 v11, v68, v70 offset0:0 offset1:1
    v_cmp_ne_u32 vcc, 0, v10
    s_nop 0
    s_cmp_lg_u64 vcc, 0
    s_addc_u32 s23, s23, s23
    s_waitcnt vmcnt(5)
    v_xor_b32 v10, v73, v239
    v_xor_b32 v11, 4224, v238
    v_bitop3_b32 v10, v10, v75, v239 bitop3:0xf6
    ds_write2_b32 v11, v72, v74 offset0:0 offset1:1
    v_cmp_ne_u32 vcc, 0, v10
    s_nop 0
    s_cmp_lg_u64 vcc, 0
    s_addc_u32 s23, s23, s23
    s_waitcnt vmcnt(4)
    v_xor_b32 v10, v77, v239
    v_xor_b32 v11, 6336, v238
    v_bitop3_b32 v10, v10, v79, v239 bitop3:0xf6
    ds_write2_b32 v11, v76, v78 offset0:0 offset1:1
    v_cmp_ne_u32 vcc, 0, v10
    s_nop 0
    s_cmp_lg_u64 vcc, 0
    s_addc_u32 s23, s23, s23
    s_waitcnt vmcnt(3)
    v_xor_b32 v10, v81, v239
    v_xor_b32 v11, 8336, v238
    v_bitop3_b32 v10, v10, v83, v239 bitop3:0xf6
    ds_write2_b32 v11, v80, v82 offset0:0 offset1:1
    v_cmp_ne_u32 vcc, 0, v10
    s_nop 0
    s_cmp_lg_u64 vcc, 0
    s_addc_u32 s23, s23, s23
    s_waitcnt vmcnt(2)
    v_xor_b32 v10, v85, v239
    v_xor_b32 v11, 10448, v238
    v_bitop3_b32 v10, v10, v87, v239 bitop3:0xf6
    ds_write2_b32 v11, v84, v86 offset0:0 offset1:1
    v_cmp_ne_u32 vcc, 0, v10
    s_nop 0
    s_cmp_lg_u64 vcc, 0
    s_addc_u32 s23, s23, s23
    s_waitcnt vmcnt(1)
    v_xor_b32 v10, v89, v239
    v_xor_b32 v11, 12304, v238
    v_bitop3_b32 v10, v10, v91, v239 bitop3:0xf6
    ds_write2_b32 v11, v88, v90 offset0:0 offset1:1
    v_cmp_ne_u32 vcc, 0, v10
    s_nop 0
    s_cmp_lg_u64 vcc, 0
    s_addc_u32 s23, s23, s23
    s_waitcnt vmcnt(0)
    v_xor_b32 v10, v93, v239
    v_xor_b32 v11, 14416, v238
    v_bitop3_b32 v10, v10, v95, v239 bitop3:0xf6
    ds_write2_b32 v11, v92, v94 offset0:0 offset1:1
    v_cmp_ne_u32 vcc, 0, v10
    s_nop 0
    s_cmp_lg_u64 vcc, 0
    s_addc_u32 s23, s23, s23
    s_mov_b32 s31, 0
    s_cmp_eq_u32 s23, 0
    s_cbranch_scc1 L_qdone
L_qretry:
    s_sleep 1
    s_bitcmp1_b32 s23, 7
    s_cbranch_scc0 Lq_19
    buffer_load_dwordx4 v[64:67], v236, s[72:75], s19 offen sc1
Lq_19:
    s_bitcmp1_b32 s23, 6
    s_cbranch_scc0 Lq_20
    buffer_load_dwordx4 v[68:71], v236, s[72:75], s20 offen sc1
Lq_20:
    s_bitcmp1_b32 s23, 5
    s_cbranch_scc0 Lq_21
    buffer_load_dwordx4 v[72:75], v236, s[72:75], s21 offen sc1
Lq_21:
    s_bitcmp1_b32 s23, 4
    s_cbranch_scc0 Lq_22
    buffer_load_dwordx4 v[76:79], v236, s[72:75], s22 offen sc1
Lq_22:
    s_bitcmp1_b32 s23, 3
    s_cbranch_scc0 Lq_23
    buffer_load_dwordx4 v[80:83], v237, s[72:75], s19 offen sc1
Lq_23:
    s_bitcmp1_b32 s23, 2
    s_cbranch_scc0 Lq_24
    buffer_load_dwordx4 v[84:87], v237, s[72:75], s20 offen sc1
Lq_24:
    s_bitcmp1_b32 s23, 1
    s_cbranch_scc0 Lq_25
    buffer_load_dwordx4 v[88:91], v237, s[72:75], s21 offen sc1
Lq_25:
    s_bitcmp1_b32 s23, 0
    s_cbranch_scc0 Lq_26
    buffer_load_dwordx4 v[92:95], v237, s[72:75], s22 offen sc1
Lq_26:
    s_waitcnt vmcnt(0)
    s_bitcmp1_b32 s23, 7
    s_cbranch_scc0 Lq_27
    v_xor_b32 v10, v65, v239
    v_bitop3_b32 v10, v10, v67, v239 bitop3:0xf6
    ds_write2_b32 v238, v64, v66 offset0:0 offset1:1
    v_cmp_ne_u32 vcc, 0, v10
    s_nop 0
    s_cmp_lg_u64 vcc, 0
    s_nop 2
    s_cbranch_scc1 Lq_27
    s_bitset0_b32 s23, 7
Lq_27:
    s_bitcmp1_b32 s23, 6
    s_cbranch_scc0 Lq_28
    v_xor_b32 v10, v69, v239
    v_xor_b32 v11, 2112, v238
    v_bitop3_b32 v10, v10, v71, v239 bitop3:0xf6
    ds_write2_b32 v11, v68, v70 offset0:0 offset1:1
    v_cmp_ne_u32 vcc, 0, v10
    s_nop 0
    s_cmp_lg_u64 vcc, 0
    s_nop 2
    s_cbranch_scc1 Lq_28
    s_bitset0_b32 s23, 6
Lq_28:
    s_bitcmp1_b32 s23, 5
    s_cbranch_scc0 Lq_29
    v_xor_b32 v10, v73, v239
    v_xor_b32 v11, 4224, v238
    v_bitop3_b32 v10, v10, v75, v239 bitop3:0xf6
    ds_write2_b32 v11, v72, v74 offset0:0 offset1:1
    v_cmp_ne_u32 vcc, 0, v10
    s_nop 0
    s_cmp_lg_u64 vcc, 0
    s_nop 2
    s_cbranch_scc1 Lq_29
    s_bitset0_b32 s23, 5
Lq_29:
    s_bitcmp1_b32 s23, 4
    s_cbranch_scc0 Lq_30
    v_xor_b32 v10, v77, v239
    v_xor_b32 v11, 6336, v238
    v_bitop3_b32 v10, v10, v79, v239 bitop3:0xf6
    ds_write2_b32 v11, v76, v78 offset0:0 offset1:1
    v_cmp_ne_u32 vcc, 0, v10
    s_nop 0
    s_cmp_lg_u64 vcc, 0
    s_nop 2
    s_cbranch_scc1 Lq_30
    s_bitset0_b32 s23, 4
Lq_30:
    s_bitcmp1_b32 s23, 3
    s_cbranch_scc0 Lq_31
    v_xor_b32 v10, v81, v239
    v_xor_b32 v11, 8336, v238
    v_bitop3_b32 v10, v10, v83, v239 bitop3:0xf6
    ds_write2_b32 v11, v80, v82 offset0:0 offset1:1
    v_cmp_ne_u32 vcc, 0, v10
    s_nop 0
    s_cmp_lg_u64 vcc, 0
    s_nop 2
    s_cbranch_scc1 Lq_31
    s_bitset0_b32 s23, 3
Lq_31:
    s_bitcmp1_b32 s23, 2
    s_cbranch_scc0 Lq_32
    v_xor_b32 v10, v85, v239
    v_xor_b32 v11, 10448, v238
    v_bitop3_b32 v10, v10, v87, v239 bitop3:0xf6
    ds_write2_b32 v11, v84, v86 offset0:0 offset1:1
    v_cmp_ne_u32 vcc, 0, v10
    s_nop 0
    s_cmp_lg_u64 vcc, 0
    s_nop 2
    s_cbranch_scc1 Lq_32
    s_bitset0_b32 s23, 2
Lq_32:
    s_bitcmp1_b32 s23, 1
    s_cbranch_scc0 Lq_33
    v_xor_b32 v10, v89, v239
    v_xor_b32 v11, 12304, v238
    v_bitop3_b32 v10, v10, v91, v239 bitop3:0xf6
    ds_write2_b32 v11, v88, v90 offset0:0 offset1:1
    v_cmp_ne_u32 vcc, 0, v10
    s_nop 0
    s_cmp_lg_u64 vcc, 0
    s_nop 2
    s_cbranch_scc1 Lq_33
    s_bitset0_b32 s23, 1
Lq_33:
    s_bitcmp1_b32 s23, 0
    s_cbranch_scc0 Lq_34
    v_xor_b32 v10, v93, v239
    v_xor_b32 v11, 14416, v238
    v_bitop3_b32 v10, v10, v95, v239 bitop3:0xf6
    ds_write2_b32 v11, v92, v94 offset0:0 offset1:1
    v_cmp_ne_u32 vcc, 0, v10
    s_nop 0
    s_cmp_lg_u64 vcc, 0
    s_nop 2
    s_cbranch_scc1 Lq_34
    s_bitset0_b32 s23, 0
Lq_34:
    s_add_u32 s31, s31, 1
    s_cmp_eq_u32 s23, 0
    s_cbranch_scc1 L_qdone
    s_cmp_lt_u32 s31, 32768
    s_cbranch_scc1 L_qretry
L_qdone:
    s_mov_b64 exec, 1
    ds_add_u32 v5, v6 offset:16
    s_mov_b64 exec, -1
    s_mov_b32 s31, 0
Lw_35:
    ds_read_b32 v31, v5 offset:16
    ds_read_b128 v[32:35], v12 offset:0
    ds_read_b128 v[36:39], v13 offset:0
    ds_read_b128 v[40:43], v14 offset:0
    ds_read_b128 v[44:47], v15 offset:0
    s_waitcnt lgkmcnt(0)
    v_readfirstlane_b32 s86, v31
    s_nop 0
    s_cmp_ge_u32 s86, 4
    s_nop 2
    s_cbranch_scc1 Lwd_36
    s_add_u32 s31, s31, 1
    s_cmp_lt_u32 s31, 1048576
    s_cbranch_scc1 Lw_35
Lwd_36:
    ds_read_b128 v[48:51], v12 offset:256
    ds_read_b128 v[52:55], v13 offset:256
    ds_read_b128 v[56:59], v14 offset:256
    ds_read_b128 v[60:63], v15 offset:256
    ds_read_b128 v[64:67], v12 offset:512
    ds_read_b128 v[68:71], v13 offset:512
    ds_read_b128 v[72:75], v14 offset:512
    ds_read_b128 v[76:79], v15 offset:512
    ds_read_b128 v[80:83], v12 offset:768
    ds_read_b128 v[84:87], v13 offset:768
    ds_read_b128 v[88:91], v14 offset:768
    ds_read_b128 v[92:95], v15 offset:768
    v_mfma_f32_16x16x32_bf16 v[224:227], v[96:99], v[32:35], 0
    v_mfma_f32_16x16x32_bf16 v[228:231], v[160:163], v[32:35], 0
    v_mfma_f32_16x16x32_bf16 v[224:227], v[100:103], v[36:39], v[224:227]
    v_mfma_f32_16x16x32_bf16 v[228:231], v[164:167], v[36:39], v[228:231]
    v_mfma_f32_16x16x32_bf16 v[224:227], v[104:107], v[40:43], v[224:227]
    ds_read_b64_tr_b16 v[96:97], v240 offset:0
    ds_read_b64_tr_b16 v[98:99], v240 offset:16384
    v_mfma_f32_16x16x32_bf16 v[228:231], v[168:171], v[40:43], v[228:231]
    ds_read_b64_tr_b16 v[160:161], v241 offset:0
    ds_read_b64_tr_b16 v[162:163], v241 offset:16384
    v_mfma_f32_16x16x32_bf16 v[224:227], v[108:111], v[44:47], v[224:227]
    ds_read_b64_tr_b16 v[100:101], v242 offset:0
    ds_read_b64_tr_b16 v[102:103], v242 offset:16384
    v_mfma_f32_16x16x32_bf16 v[228:231], v[172:175], v[44:47], v[228:231]
    ds_read_b64_tr_b16 v[164:165], v243 offset:0
    ds_read_b64_tr_b16 v[166:167], v243 offset:16384
    s_waitcnt lgkmcnt(15)
    v_mfma_f32_16x16x32_bf16 v[224:227], v[112:115], v[48:51], v[224:227]
    ds_read_b64_tr_b16 v[104:105], v240 offset:32768
    ds_read_b64_tr_b16 v[106:107], v240 offset:49152
    v_mfma_f32_16x16x32_bf16 v[228:231], v[176:179], v[48:51], v[228:231]
    ds_read_b64_tr_b16 v[168:169], v241 offset:32768
    ds_read_b64_tr_b16 v[170:171], v241 offset:49152
    s_waitcnt lgkmcnt(15)
    v_mfma_f32_16x16x32_bf16 v[224:227], v[116:119], v[52:55], v[224:227]
    ds_read_b64_tr_b16 v[108:109], v242 offset:32768
    ds_read_b64_tr_b16 v[110:111], v242 offset:49152
    v_mfma_f32_16x16x32_bf16 v[228:231], v[180:183], v[52:55], v[228:231]
    ds_read_b64_tr_b16 v[172:173], v243 offset:32768
    ds_read_b64_tr_b16 v[174:175], v243 offset:49152
    s_waitcnt lgkmcnt(15)
    v_mfma_f32_16x16x32_bf16 v[224:227], v[120:123], v[56:59], v[224:227]
    ds_read_b64_tr_b16 v[112:113], v248 offset:0
    ds_read_b64_tr_b16 v[114:115], v248 offset:16384
    v_mfma_f32_16x16x32_bf16 v[228:231], v[184:187], v[56:59], v[228:231]
    ds_read_b64_tr_b16 v[176:177], v249 offset:0
    ds_read_b64_tr_b16 v[178:179], v249 offset:16384
    s_waitcnt lgkmcnt(15)
    v_mfma_f32_16x16x32_bf16 v[224:227], v[124:127], v[60:63], v[224:227]
    ds_read_b64_tr_b16 v[116:117], v250 offset:0
    ds_read_b64_tr_b16 v[118:119], v250 offset:16384
    v_mfma_f32_16x16x32_bf16 v[228:231], v[188:191], v[60:63], v[228:231]
    ds_read_b64_tr_b16 v[180:181], v251 offset:0
    ds_read_b64_tr_b16 v[182:183], v251 offset:16384
    s_waitcnt lgkmcnt(15)
    v_mfma_f32_16x16x32_bf16 v[224:227], v[128:131], v[64:67], v[224:227]
    ds_read_b64_tr_b16 v[120:121], v248 offset:32768
    ds_read_b64_tr_b16 v[122:123], v248 offset:49152
    v_mfma_f32_16x16x32_bf16 v[228:231], v[192:195], v[64:67], v[228:231]
    ds_read_b64_tr_b16 v[184:185], v249 offset:32768
    ds_read_b64_tr_b16 v[186:187], v249 offset:49152
    s_waitcnt lgkmcnt(15)
    v_mfma_f32_16x16x32_bf16 v[224:227], v[132:135], v[68:71], v[224:227]
    ds_read_b64_tr_b16 v[124:125], v250 offset:32768
    ds_read_b64_tr_b16 v[126:127], v250 offset:49152
    v_mfma_f32_16x16x32_bf16 v[228:231], v[196:199], v[68:71], v[228:231]
    ds_read_b64_tr_b16 v[188:189], v251 offset:32768
    ds_read_b64_tr_b16 v[190:191], v251 offset:49152
    s_waitcnt lgkmcnt(15)
    v_mfma_f32_16x16x32_bf16 v[224:227], v[136:139], v[72:75], v[224:227]
    ds_read_b64_tr_b16 v[128:129], v244 offset:0
    ds_read_b64_tr_b16 v[130:131], v244 offset:16384
    v_mfma_f32_16x16x32_bf16 v[228:231], v[200:203], v[72:75], v[228:231]
    ds_read_b64_tr_b16 v[192:193], v245 offset:0
    ds_read_b64_tr_b16 v[194:195], v245 offset:16384
    s_waitcnt lgkmcnt(15)
    v_mfma_f32_16x16x32_bf16 v[224:227], v[140:143], v[76:79], v[224:227]
    ds_read_b64_tr_b16 v[132:133], v246 offset:0
    ds_read_b64_tr_b16 v[134:135], v246 offset:16384
    v_mfma_f32_16x16x32_bf16 v[228:231], v[204:207], v[76:79], v[228:231]
    ds_read_b64_tr_b16 v[196:197], v247 offset:0
    ds_read_b64_tr_b16 v[198:199], v247 offset:16384
    s_waitcnt lgkmcnt(15)
    v_mfma_f32_16x16x32_bf16 v[224:227], v[144:147], v[80:83], v[224:227]
    ds_read_b64_tr_b16 v[136:137], v244 offset:32768
    ds_read_b64_tr_b16 v[138:139], v244 offset:49152
    v_mfma_f32_16x16x32_bf16 v[228:231], v[208:211], v[80:83], v[228:231]
    ds_read_b64_tr_b16 v[200:201], v245 offset:32768
    ds_read_b64_tr_b16 v[202:203], v245 offset:49152
    s_waitcnt lgkmcnt(15)
    v_mfma_f32_16x16x32_bf16 v[224:227], v[148:151], v[84:87], v[224:227]
    ds_read_b64_tr_b16 v[140:141], v246 offset:32768
    ds_read_b64_tr_b16 v[142:143], v246 offset:49152
    v_mfma_f32_16x16x32_bf16 v[228:231], v[212:215], v[84:87], v[228:231]
    ds_read_b64_tr_b16 v[204:205], v247 offset:32768
    ds_read_b64_tr_b16 v[206:207], v247 offset:49152
    s_waitcnt lgkmcnt(15)
    v_mfma_f32_16x16x32_bf16 v[224:227], v[152:155], v[88:91], v[224:227]
    ds_read_b64_tr_b16 v[144:145], v252 offset:0
    ds_read_b64_tr_b16 v[146:147], v252 offset:16384
    v_mfma_f32_16x16x32_bf16 v[228:231], v[216:219], v[88:91], v[228:231]
    ds_read_b64_tr_b16 v[208:209], v253 offset:0
    ds_read_b64_tr_b16 v[210:211], v253 offset:16384
    s_waitcnt lgkmcnt(15)
    v_mfma_f32_16x16x32_bf16 v[224:227], v[156:159], v[92:95], v[224:227]
    ds_read_b64_tr_b16 v[148:149], v254 offset:0
    ds_read_b64_tr_b16 v[150:151], v254 offset:16384
    v_mfma_f32_16x16x32_bf16 v[228:231], v[220:223], v[92:95], v[228:231]
    ds_read_b64_tr_b16 v[212:213], v255 offset:0
    ds_read_b64_tr_b16 v[214:215], v255 offset:16384
    ds_read_b64_tr_b16 v[152:153], v252 offset:32768
    ds_read_b64_tr_b16 v[154:155], v252 offset:49152
    ds_read_b64_tr_b16 v[216:217], v253 offset:32768
    ds_read_b64_tr_b16 v[218:219], v253 offset:49152
    v_max3_f32 v9, v224, v225, v226
    s_nop 0
    v_max3_f32 v10, v227, v228, v229
    v_max3_f32 v9, v9, v230, v231
    v_max_f32 v9, v9, v10
    v_ceil_f32 v19, v9
    ds_max_f32 v16, v19
    ds_add_u32 v16, v6 offset:4
    ds_read_b64 v[232:233], v16
    ds_read_b64_tr_b16 v[156:157], v254 offset:32768
    ds_read_b64_tr_b16 v[158:159], v254 offset:49152
    ds_read_b64_tr_b16 v[220:221], v255 offset:32768
    ds_read_b64_tr_b16 v[222:223], v255 offset:49152
    v_sub_f32 v224, v224, v19
    v_sub_f32 v225, v225, v19
    v_sub_f32 v226, v226, v19
    v_sub_f32 v227, v227, v19
    v_sub_f32 v228, v228, v19
    v_sub_f32 v229, v229, v19
    v_sub_f32 v230, v230, v19
    v_sub_f32 v231, v231, v19
    v_exp_f32 v224, v224
    v_exp_f32 v225, v225
    v_exp_f32 v226, v226
    v_exp_f32 v227, v227
    v_exp_f32 v228, v228
    v_exp_f32 v229, v229
    v_exp_f32 v230, v230
    v_exp_f32 v231, v231
    s_mov_b32 s31, 0
    s_waitcnt lgkmcnt(4)
    s_branch Lmc_39
Lm_37:
    ds_read_b64 v[232:233], v16
    s_waitcnt lgkmcnt(0)
Lmc_39:
    v_cmp_ne_u32 vcc, 16, v233
    v_sub_f32 v9, v19, v232
    s_cmp_eq_u64 vcc, 0
    s_nop 2
    s_cbranch_scc1 Lmd_38
    s_add_u32 s31, s31, 1
    s_cmp_lt_u32 s31, 1048576
    s_cbranch_scc1 Lm_37
Lmd_38:
    v_exp_f32 v9, v9
    s_nop 0
    v_mul_f32 v224, v224, v9
    v_mul_f32 v225, v225, v9
    v_mul_f32 v226, v226, v9
    v_mul_f32 v227, v227, v9
    v_mul_f32 v228, v228, v9
    v_mul_f32 v229, v229, v9
    v_mul_f32 v230, v230, v9
    v_mul_f32 v231, v231, v9
    v_cvt_pk_bf16_f32 v32, v224, v225
    v_cvt_pk_bf16_f32 v33, v226, v227
    v_cvt_pk_bf16_f32 v34, v228, v229
    v_cvt_pk_bf16_f32 v35, v230, v231
    ds_write_b128 v17, v[32:35]
    s_mov_b64 exec, 1
    ds_add_u32 v5, v6 offset:20
    s_mov_b64 exec, -1
    s_mov_b32 s31, 0
Lw_40:
    ds_read_b32 v31, v5 offset:20
    ds_read_b128 v[32:35], v18 offset:0
    ds_read_b128 v[36:39], v18 offset:1024
    ds_read_b128 v[40:43], v18 offset:2048
    ds_read_b128 v[44:47], v18 offset:3072
    v_mov_b32 v224, 0x3f803f80
    v_mov_b32 v225, 0x3f803f80
    v_mov_b32 v226, 0x3f803f80
    v_mov_b32 v227, 0x3f803f80
    s_waitcnt lgkmcnt(0)
    v_readfirstlane_b32 s86, v31
    s_nop 0
    s_cmp_ge_u32 s86, 4
    s_nop 2
    s_cbranch_scc1 Lwd_41
    s_add_u32 s31, s31, 1
    s_cmp_lt_u32 s31, 1048576
    s_cbranch_scc1 Lw_40
Lwd_41:
    s_mov_b64 exec, 1
    ds_add_u32 v5, v6 offset:68
    s_mov_b64 exec, -1
    v_mfma_f32_16x16x32_bf16 v[48:51], v[96:99], v[32:35], 0
    v_mfma_f32_16x16x32_bf16 v[52:55], v[160:163], v[32:35], 0
    v_mfma_f32_16x16x32_bf16 v[56:59], v[100:103], v[32:35], 0
    v_mfma_f32_16x16x32_bf16 v[60:63], v[164:167], v[32:35], 0
    v_mfma_f32_16x16x32_bf16 v[48:51], v[104:107], v[36:39], v[48:51]
    v_mfma_f32_16x16x32_bf16 v[52:55], v[168:171], v[36:39], v[52:55]
    v_mfma_f32_16x16x32_bf16 v[56:59], v[108:111], v[36:39], v[56:59]
    v_mfma_f32_16x16x32_bf16 v[60:63], v[172:175], v[36:39], v[60:63]
    v_mfma_f32_16x16x32_bf16 v[48:51], v[112:115], v[40:43], v[48:51]
    v_mfma_f32_16x16x32_bf16 v[52:55], v[176:179], v[40:43], v[52:55]
    v_mfma_f32_16x16x32_bf16 v[56:59], v[116:119], v[40:43], v[56:59]
    v_mfma_f32_16x16x32_bf16 v[60:63], v[180:183], v[40:43], v[60:63]
    v_mfma_f32_16x16x32_bf16 v[48:51], v[120:123], v[44:47], v[48:51]
    v_mfma_f32_16x16x32_bf16 v[52:55], v[184:187], v[44:47], v[52:55]
    v_mfma_f32_16x16x32_bf16 v[56:59], v[124:127], v[44:47], v[56:59]
    v_mfma_f32_16x16x32_bf16 v[60:63], v[188:191], v[44:47], v[60:63]
    v_mfma_f32_16x16x32_bf16 v[64:67], v[128:131], v[32:35], 0
    v_mfma_f32_16x16x32_bf16 v[68:71], v[192:195], v[32:35], 0
    v_mfma_f32_16x16x32_bf16 v[72:75], v[132:135], v[32:35], 0
    s_nop 1
    v_cvt_pk_bf16_f32 v80, v48, v49
    v_cvt_pk_bf16_f32 v81, v50, v51
    v_mfma_f32_16x16x32_bf16 v[76:79], v[196:199], v[32:35], 0
    v_cvt_pk_bf16_f32 v82, v52, v53
    v_cvt_pk_bf16_f32 v83, v54, v55
    v_mfma_f32_16x16x32_bf16 v[64:67], v[136:139], v[36:39], v[64:67]
    v_cvt_pk_bf16_f32 v84, v56, v57
    v_cvt_pk_bf16_f32 v85, v58, v59
    v_mfma_f32_16x16x32_bf16 v[68:71], v[200:203], v[36:39], v[68:71]
    v_cvt_pk_bf16_f32 v86, v60, v61
    v_cvt_pk_bf16_f32 v87, v62, v63
    v_mfma_f32_16x16x32_bf16 v[72:75], v[140:143], v[36:39], v[72:75]
    v_permlane16_swap_b32 v80, v82
    v_permlane16_swap_b32 v81, v83
    v_mfma_f32_16x16x32_bf16 v[76:79], v[204:207], v[36:39], v[76:79]
    v_permlane16_swap_b32 v84, v86
    v_permlane16_swap_b32 v85, v87
    v_mfma_f32_16x16x32_bf16 v[64:67], v[144:147], v[40:43], v[64:67]
    v_mov_b32 v48, v80
    v_mov_b32 v49, v81
    v_mfma_f32_16x16x32_bf16 v[68:71], v[208:211], v[40:43], v[68:71]
    v_mov_b32 v50, v82
    v_mov_b32 v51, v83
    v_mfma_f32_16x16x32_bf16 v[72:75], v[148:151], v[40:43], v[72:75]
    v_mov_b32 v52, v84
    v_mov_b32 v53, v85
    v_mfma_f32_16x16x32_bf16 v[76:79], v[212:215], v[40:43], v[76:79]
    v_mov_b32 v54, v86
    v_mov_b32 v55, v87
    v_mfma_f32_16x16x32_bf16 v[64:67], v[152:155], v[44:47], v[64:67]
    v_mov_b32_dpp v48, v84 row_ror:8 row_mask:0xf bank_mask:0xc
    v_mov_b32_dpp v49, v85 row_ror:8 row_mask:0xf bank_mask:0xc
    v_mfma_f32_16x16x32_bf16 v[68:71], v[216:219], v[44:47], v[68:71]
    v_mov_b32_dpp v50, v86 row_ror:8 row_mask:0xf bank_mask:0xc
    v_mov_b32_dpp v51, v87 row_ror:8 row_mask:0xf bank_mask:0xc
    v_mfma_f32_16x16x32_bf16 v[72:75], v[156:159], v[44:47], v[72:75]
    buffer_store_dwordx4 v[48:51], v22, s[72:75], s24 offen offset:0 sc1
    v_mov_b32_dpp v52, v80 row_ror:8 row_mask:0xf bank_mask:0x3
    v_mfma_f32_16x16x32_bf16 v[76:79], v[220:223], v[44:47], v[76:79]
    v_mov_b32_dpp v53, v81 row_ror:8 row_mask:0xf bank_mask:0x3
    v_mov_b32_dpp v54, v82 row_ror:8 row_mask:0xf bank_mask:0x3
    v_mfma_f32_16x16x32_bf16 v[228:231], v[224:227], v[32:35], 0
    v_mov_b32_dpp v55, v83 row_ror:8 row_mask:0xf bank_mask:0x3
    buffer_store_dwordx4 v[52:55], v22, s[72:75], s16 offen offset:0 sc1
    v_mfma_f32_16x16x32_bf16 v[228:231], v[224:227], v[36:39], v[228:231]
    v_add_u32 v234, v80, v81
    v_add3_u32 v234, v234, v82, v83
    v_mfma_f32_16x16x32_bf16 v[228:231], v[224:227], v[40:43], v[228:231]
    v_add3_u32 v234, v234, v84, v85
    v_add3_u32 v234, v234, v86, v87
    v_mfma_f32_16x16x32_bf16 v[228:231], v[224:227], v[44:47], v[228:231]
    v_cvt_pk_bf16_f32 v88, v64, v65
    v_cvt_pk_bf16_f32 v89, v66, v67
    v_cvt_pk_bf16_f32 v90, v68, v69
    v_cvt_pk_bf16_f32 v91, v70, v71
    v_cvt_pk_bf16_f32 v92, v72, v73
    v_cvt_pk_bf16_f32 v93, v74, v75
    v_cvt_pk_bf16_f32 v94, v76, v77
    v_cvt_pk_bf16_f32 v95, v78, v79
    v_permlane16_swap_b32 v88, v90
    v_permlane16_swap_b32 v89, v91
    v_permlane16_swap_b32 v92, v94
    v_permlane16_swap_b32 v93, v95
    v_mov_b32 v64, v88
    v_mov_b32 v65, v89
    v_mov_b32 v66, v90
    v_mov_b32 v67, v91
    v_mov_b32 v68, v92
    v_mov_b32 v69, v93
    v_mov_b32 v70, v94
    v_mov_b32 v71, v95
    v_mov_b32_dpp v64, v92 row_ror:8 row_mask:0xf bank_mask:0xc
    v_mov_b32_dpp v65, v93 row_ror:8 row_mask:0xf bank_mask:0xc
    v_mov_b32_dpp v66, v94 row_ror:8 row_mask:0xf bank_mask:0xc
    v_mov_b32_dpp v67, v95 row_ror:8 row_mask:0xf bank_mask:0xc
    buffer_store_dwordx4 v[64:67], v22, s[72:75], s24 offen offset:128 sc1
    v_mov_b32_dpp v68, v88 row_ror:8 row_mask:0xf bank_mask:0x3
    v_mov_b32_dpp v69, v89 row_ror:8 row_mask:0xf bank_mask:0x3
    v_mov_b32_dpp v70, v90 row_ror:8 row_mask:0xf bank_mask:0x3
    v_mov_b32_dpp v71, v91 row_ror:8 row_mask:0xf bank_mask:0x3
    buffer_store_dwordx4 v[68:71], v22, s[72:75], s16 offen offset:128 sc1
    v_add3_u32 v234, v234, v88, v89
    v_add3_u32 v234, v234, v90, v91
    v_add3_u32 v234, v234, v92, v93
    v_add3_u32 v234, v234, v94, v95
    s_lshl_b32 s17, s10, 7
    s_add_u32 s17, s17, s11
    s_lshl_b32 s17, s17, 2
    s_add_u32 s17, s17, s3
    s_lshl_b32 s17, s17, 8
    s_add_u32 s17, s17, 6291456
    v_mov_b32 v8, v234
    v_mov_b32 v233, v228
    s_nop 0
    v_permlane32_swap_b32 v234, v8
    v_add_u32 v234, v234, v8
    v_mov_b32 v8, v234
    v_xor_b32 v9, s12, v232
    s_nop 0
    v_permlane16_swap_b32 v234, v8
    v_add3_u32 v234, v234, v8, s12
    v_xor_b32 v235, v9, v233
    s_mov_b64 exec, 0xffff
    buffer_store_dwordx4 v[232:235], v4, s[72:75], s17 offen sc1
    s_mov_b64 exec, -1
    v_lshlrev_b32 v8, 8, v3
    v_lshl_add_u32 v8, v2, 4, v8
    v_add_u32 v19, 4096, v8
    s_lshl_b32 s13, s6, 2
    s_add_u32 s13, s13, s8
    s_lshl_b32 s13, s13, 15
    s_lshl_b32 s15, s3, 13
    s_add_u32 s13, s13, s15
    s_add_u32 s13, s13, 2097152
    v_and_b32 v9, 7, v2
    v_lshrrev_b32 v10, 3, v2
    v_xor_b32 v10, v10, v3
    v_lshl_add_u32 v9, v9, 2, v10
    v_lshlrev_b32 v9, 10, v9
    v_xor_b32 v10, 2048, v9
    s_lshr_b32 s17, s6, 4
    s_lshl_b32 s17, s17, 2
    s_add_u32 s17, s17, s3
    s_lshl_b32 s17, s17, 15
    s_and_b32 s18, s6, 15
    s_lshl_b32 s18, s18, 4
    s_add_u32 s17, s17, s18
    s_lshl_b32 s18, s8, 8
    s_add_u32 s17, s17, s18
    s_add_u32 s17, s17, 6291456
    v_and_b32 v11, 1, v2
    v_lshlrev_b32 v11, 4, v11
    v_mov_b32 v12, 0xffff
    v_lshlrev_b32 v11, v11, v12
    v_lshrrev_b32 v12, 1, v2
    v_cmp_eq_u32 vcc, 0, v12
    s_nop 1
    v_cndmask_b32 v72, 0, v11, vcc
    v_cmp_eq_u32 vcc, 1, v12
    s_nop 1
    v_cndmask_b32 v73, 0, v11, vcc
    v_cmp_eq_u32 vcc, 2, v12
    s_nop 1
    v_cndmask_b32 v74, 0, v11, vcc
    v_cmp_eq_u32 vcc, 3, v12
    s_nop 1
    v_cndmask_b32 v75, 0, v11, vcc
    s_mul_i32 s18, s3, 272
    s_add_u32 s18, s18, 157248
    v_lshlrev_b32 v18, 4, v2
    v_lshl_add_u32 v18, v3, 3, v18
    v_add_u32 v18, s18, v18
    s_mov_b32 s19, 0x03020302
    s_waitcnt vmcnt(0)
    s_mov_b32 s31, 0
    s_mov_b64 exec, s[82:83]
L_pollm:
    buffer_load_dwordx4 v[64:67], v9, s[72:75], s17 offen sc1
    s_waitcnt vmcnt(0)
    v_bitop3_b32 v17, v64, v65, v67 bitop3:0x96
    v_cmp_ne_u32 vcc, s12, v17
    s_nop 0
    s_bcnt1_i32_b64 s86, vcc
    s_cmp_le_u32 s86, 4
    s_nop 1
    s_cbranch_scc1 L_pollmd
    s_mov_b64 exec, vcc
    s_sleep 2
    s_add_u32 s31, s31, 1
    s_cmp_lt_u32 s31, 32768
    s_cbranch_scc1 L_pollm
L_pollmd:
    s_mov_b64 exec, -1
    s_mov_b32 s31, 0
L_pollc:
    buffer_load_dwordx4 v[64:67], v9, s[72:75], s17 offen sc1
    buffer_load_dwordx4 v[68:71], v10, s[72:75], s17 offen sc1
    buffer_load_dwordx4 v[32:35], v8, s[72:75], s13 offen offset:0 sc1
    buffer_load_dwordx4 v[36:39], v8, s[72:75], s13 offen offset:1024 sc1
    buffer_load_dwordx4 v[40:43], v8, s[72:75], s13 offen offset:2048 sc1
    buffer_load_dwordx4 v[44:47], v8, s[72:75], s13 offen offset:3072 sc1
    buffer_load_dwordx4 v[48:51], v19, s[72:75], s13 offen offset:0 sc1
    buffer_load_dwordx4 v[52:55], v19, s[72:75], s13 offen offset:1024 sc1
    buffer_load_dwordx4 v[56:59], v19, s[72:75], s13 offen offset:2048 sc1
    buffer_load_dwordx4 v[60:63], v19, s[72:75], s13 offen offset:3072 sc1
    s_waitcnt vmcnt(8)
    v_bitop3_b32 v17, v64, v65, v67 bitop3:0x96
    v_bitop3_b32 v11, v68, v69, v71 bitop3:0x96
    v_cmp_ne_u32 vcc, s12, v17
    v_cmp_ne_u32 s[86:87], s12, v11
    s_nop 0
    s_or_b64 vcc, s[86:87], vcc
    s_nop 2
    s_cbranch_scc0 L_entok
    s_waitcnt vmcnt(0)
    s_add_u32 s31, s31, 1
    s_cmp_lt_u32 s31, 32768
    s_cbranch_scc1 L_pollc
L_entok:
    v_max_f32 v12, v64, v68
    s_nop 1
    v_max_f32_dpp v12, v12, v12 row_ror:1 row_mask:0xf bank_mask:0xf
    s_nop 1
    v_max_f32_dpp v12, v12, v12 row_ror:2 row_mask:0xf bank_mask:0xf
    v_sub_u32 v16, s12, v66
    s_nop 0
    v_max_f32_dpp v12, v12, v12 row_ror:4 row_mask:0xf bank_mask:0xf
    v_cndmask_b32 v16, 0, v16, s[82:83]
    s_nop 0
    v_max_f32_dpp v12, v12, v12 row_ror:8 row_mask:0xf bank_mask:0xf
    v_sub_f32 v13, v64, v12
    v_sub_f32 v14, v68, v12
    v_exp_f32 v13, v13
    v_exp_f32 v14, v14
    v_perm_b32 v15, v13, v13, s19
    v_mul_f32 v13, v13, v65
    v_fmac_f32 v13, v14, v69
    v_and_b32_dpp v76, v15, v72 row_newbcast:0 row_mask:0xf bank_mask:0xf
    v_and_b32_dpp v77, v15, v73 row_newbcast:0 row_mask:0xf bank_mask:0xf
    v_and_b32_dpp v78, v15, v74 row_newbcast:0 row_mask:0xf bank_mask:0xf
    v_and_b32_dpp v79, v15, v75 row_newbcast:0 row_mask:0xf bank_mask:0xf
    v_add_f32_dpp v13, v13, v13 row_ror:1 row_mask:0xf bank_mask:0xf
    s_waitcnt vmcnt(7)
    v_add3_u32 v16, v16, v32, v33
    v_mfma_f32_16x16x32_bf16 v[84:87], v[76:79], v[32:35], 0
    v_add3_u32 v16, v16, v34, v35
    v_and_b32_dpp v80, v15, v72 row_newbcast:1 row_mask:0xf bank_mask:0xf
    v_and_b32_dpp v81, v15, v73 row_newbcast:1 row_mask:0xf bank_mask:0xf
    v_and_b32_dpp v82, v15, v74 row_newbcast:1 row_mask:0xf bank_mask:0xf
    v_and_b32_dpp v83, v15, v75 row_newbcast:1 row_mask:0xf bank_mask:0xf
    v_add_f32_dpp v13, v13, v13 row_ror:2 row_mask:0xf bank_mask:0xf
    s_waitcnt vmcnt(6)
    v_add3_u32 v16, v16, v36, v37
    v_mfma_f32_16x16x32_bf16 v[84:87], v[80:83], v[36:39], v[84:87]
    v_add3_u32 v16, v16, v38, v39
    v_and_b32_dpp v76, v15, v72 row_newbcast:2 row_mask:0xf bank_mask:0xf
    v_and_b32_dpp v77, v15, v73 row_newbcast:2 row_mask:0xf bank_mask:0xf
    v_and_b32_dpp v78, v15, v74 row_newbcast:2 row_mask:0xf bank_mask:0xf
    v_and_b32_dpp v79, v15, v75 row_newbcast:2 row_mask:0xf bank_mask:0xf
    v_add_f32_dpp v13, v13, v13 row_ror:4 row_mask:0xf bank_mask:0xf
    s_waitcnt vmcnt(5)
    v_add3_u32 v16, v16, v40, v41
    v_mfma_f32_16x16x32_bf16 v[84:87], v[76:79], v[40:43], v[84:87]
    v_add3_u32 v16, v16, v42, v43
    v_and_b32_dpp v80, v15, v72 row_newbcast:3 row_mask:0xf bank_mask:0xf
    v_and_b32_dpp v81, v15, v73 row_newbcast:3 row_mask:0xf bank_mask:0xf
    v_and_b32_dpp v82, v15, v74 row_newbcast:3 row_mask:0xf bank_mask:0xf
    v_and_b32_dpp v83, v15, v75 row_newbcast:3 row_mask:0xf bank_mask:0xf
    v_add_f32_dpp v13, v13, v13 row_ror:8 row_mask:0xf bank_mask:0xf
    s_waitcnt vmcnt(4)
    v_add3_u32 v16, v16, v44, v45
    v_mfma_f32_16x16x32_bf16 v[84:87], v[80:83], v[44:47], v[84:87]
    v_add3_u32 v16, v16, v46, v47
    v_and_b32_dpp v76, v15, v72 row_newbcast:4 row_mask:0xf bank_mask:0xf
    v_and_b32_dpp v77, v15, v73 row_newbcast:4 row_mask:0xf bank_mask:0xf
    v_and_b32_dpp v78, v15, v74 row_newbcast:4 row_mask:0xf bank_mask:0xf
    v_and_b32_dpp v79, v15, v75 row_newbcast:4 row_mask:0xf bank_mask:0xf
    v_rcp_f32 v13, v13
    s_waitcnt vmcnt(3)
    v_add3_u32 v16, v16, v48, v49
    v_mfma_f32_16x16x32_bf16 v[84:87], v[76:79], v[48:51], v[84:87]
    v_add3_u32 v16, v16, v50, v51
    v_and_b32_dpp v80, v15, v72 row_newbcast:5 row_mask:0xf bank_mask:0xf
    v_and_b32_dpp v81, v15, v73 row_newbcast:5 row_mask:0xf bank_mask:0xf
    v_and_b32_dpp v82, v15, v74 row_newbcast:5 row_mask:0xf bank_mask:0xf
    v_and_b32_dpp v83, v15, v75 row_newbcast:5 row_mask:0xf bank_mask:0xf
    s_waitcnt vmcnt(2)
    v_add3_u32 v16, v16, v52, v53
    v_mfma_f32_16x16x32_bf16 v[84:87], v[80:83], v[52:55], v[84:87]
    v_add3_u32 v16, v16, v54, v55
    v_and_b32_dpp v76, v15, v72 row_newbcast:6 row_mask:0xf bank_mask:0xf
    v_and_b32_dpp v77, v15, v73 row_newbcast:6 row_mask:0xf bank_mask:0xf
    v_and_b32_dpp v78, v15, v74 row_newbcast:6 row_mask:0xf bank_mask:0xf
    v_and_b32_dpp v79, v15, v75 row_newbcast:6 row_mask:0xf bank_mask:0xf
    s_waitcnt vmcnt(1)
    v_add3_u32 v16, v16, v56, v57
    v_mfma_f32_16x16x32_bf16 v[84:87], v[76:79], v[56:59], v[84:87]
    v_add3_u32 v16, v16, v58, v59
    v_and_b32_dpp v80, v15, v72 row_newbcast:7 row_mask:0xf bank_mask:0xf
    v_and_b32_dpp v81, v15, v73 row_newbcast:7 row_mask:0xf bank_mask:0xf
    v_and_b32_dpp v82, v15, v74 row_newbcast:7 row_mask:0xf bank_mask:0xf
    v_and_b32_dpp v83, v15, v75 row_newbcast:7 row_mask:0xf bank_mask:0xf
    s_waitcnt vmcnt(0)
    v_add3_u32 v16, v16, v60, v61
    v_mfma_f32_16x16x32_bf16 v[84:87], v[80:83], v[60:63], v[84:87]
    v_add3_u32 v16, v16, v62, v63
    s_nop 1
    v_add_u32_dpp v16, v16, v16 row_ror:1 row_mask:0xf bank_mask:0xf
    s_nop 1
    v_add_u32_dpp v16, v16, v16 row_ror:2 row_mask:0xf bank_mask:0xf
    s_nop 1
    v_add_u32_dpp v16, v16, v16 row_ror:4 row_mask:0xf bank_mask:0xf
    s_nop 1
    v_add_u32_dpp v16, v16, v16 row_ror:8 row_mask:0xf bank_mask:0xf
    v_cmp_ne_u32 vcc, 0, v16
    v_mul_f32 v84, v84, v13
    v_mul_f32 v85, v85, v13
    v_mul_f32 v86, v86, v13
    v_mul_f32 v87, v87, v13
    v_cvt_pk_bf16_f32 v88, v84, v85
    v_cvt_pk_bf16_f32 v89, v86, v87
    s_cmp_eq_u64 vcc, 0
    s_nop 0
    s_cbranch_scc1 Lpd_42
    s_add_u32 s31, s31, 1
    s_cmp_lt_u32 s31, 32768
    s_cbranch_scc1 L_pollc
Lpd_42:
    s_mov_b32 exec_hi, 0
    ds_write_b64 v18, v[88:89]
    s_mov_b64 exec, 1
    ds_add_u32 v5, v6 offset:76
    s_mov_b64 exec, -1
    s_setprio 0
    s_cmp_eq_u32 s29, 1
    s_cbranch_scc1 L_ffn
    s_cmp_eq_u32 s30, 0
    s_cbranch_scc1 L_fin
    v_and_b32 v96, 0x3f803f80, v72
    v_and_b32 v97, 0x3f803f80, v73
    v_and_b32 v98, 0x3f803f80, v74
    v_and_b32 v99, 0x3f803f80, v75
    v_and_b32 v8, 0x23, v1
    v_bfe_u32 v9, v1, 2, 1
    v_lshl_add_u32 v8, v9, 4, v8
    v_bfe_u32 v9, v1, 3, 2
    v_lshl_add_u32 v8, v9, 2, v8
    v_lshlrev_b32 v12, 1, v8
    s_lshl_b32 s13, s28, 7
    buffer_load_ushort v13, v12, s[32:35], s13 offen
    v_lshlrev_b32 v8, 4, v0
    s_lshl_b32 s14, s28, 14
    s_add_u32 s14, s14, 524288
    s_add_u32 s15, s14, 4096
    s_add_u32 s16, s14, 8192
    s_add_u32 s17, s14, 12288
    s_lshl_b32 s18, s3, 8
    s_add_u32 s18, s18, 160576
    v_lshlrev_b32 v9, 5, v2
    v_lshl_add_u32 v9, v3, 4, v9
    v_add_u32 v9, s18, v9
    v_lshlrev_b32 v10, 2, v1
    v_add_u32 v10, 160576, v10
    s_mul_i32 s18, s28, 12288
    s_add_u32 s18, s18, 1048576
    s_add_u32 s76, s72, s18
    s_addc_u32 s77, s73, 0
    s_mov_b32 s19, 4096
    s_mov_b32 s20, 8192
    s_waitcnt vmcnt(0)
    s_barrier
    s_mov_b32 s31, 0
L_pollr1:
    buffer_load_dwordx4 v[100:103], v8, s[72:75], s14 offen sc1
    buffer_load_dwordx4 v[104:107], v8, s[72:75], s15 offen sc1
    buffer_load_dwordx4 v[108:111], v8, s[72:75], s16 offen sc1
    buffer_load_dwordx4 v[112:115], v8, s[72:75], s17 offen sc1
    s_waitcnt vmcnt(3)
    v_max3_u32 v11, v100, v101, v102
    v_mfma_f32_16x16x32_bf16 v[116:119], v[96:99], v[100:103], 0
    v_max_u32 v11, v11, v103
    s_waitcnt vmcnt(2)
    v_max3_u32 v11, v11, v104, v105
    v_mfma_f32_16x16x32_bf16 v[116:119], v[96:99], v[104:107], v[116:119]
    v_max3_u32 v11, v11, v106, v107
    s_waitcnt vmcnt(1)
    v_max3_u32 v11, v11, v108, v109
    v_mfma_f32_16x16x32_bf16 v[116:119], v[96:99], v[108:111], v[116:119]
    v_max3_u32 v11, v11, v110, v111
    s_waitcnt vmcnt(0)
    v_max3_u32 v11, v11, v112, v113
    v_mfma_f32_16x16x32_bf16 v[116:119], v[96:99], v[112:115], v[116:119]
    v_max3_u32 v11, v11, v114, v115
    v_cmp_eq_u32 vcc, -1, v11
    s_nop 0
    s_cmp_eq_u64 vcc, 0
    s_nop 3
    s_cbranch_scc1 Lpd_43
    s_add_u32 s31, s31, 1
    s_cmp_lt_u32 s31, 32768
    s_cbranch_scc1 L_pollr1
Lpd_43:
    v_add_f32_dpp v116, v116, v116 row_ror:8 row_mask:0xf bank_mask:0xf
    v_add_f32_dpp v117, v117, v117 row_ror:8 row_mask:0xf bank_mask:0xf
    v_add_f32_dpp v118, v118, v118 row_ror:8 row_mask:0xf bank_mask:0xf
    v_add_f32_dpp v119, v119, v119 row_ror:8 row_mask:0xf bank_mask:0xf
    s_mov_b64 exec, 0x00ff00ff
    ds_write_b128 v9, v[116:119]
    s_mov_b64 exec, -1
    s_waitcnt lgkmcnt(0)
    s_barrier
    s_cmp_lg_u32 s3, 0
    s_cbranch_scc1 L_r1skip
    ds_read2st64_b32 v[120:121], v10 offset0:0 offset1:1
    ds_read2st64_b32 v[122:123], v10 offset0:2 offset1:3
    s_waitcnt lgkmcnt(0)
    v_add_f32 v120, v120, v121
    v_add_f32 v122, v122, v123
    v_add_f32 v120, v120, v122
    v_cvt_pk_bf16_f32 v120, v120, v120
    v_and_b32 v120, 0xffff0000, v120
    v_lshlrev_b32 v13, 16, v13
    v_add_f32 v128, v120, v13
    s_add_u32 s18, s13, 360448
    s_nop 0
    v_mov_b32_dpp v122, v128 quad_perm:[1,1,3,3] row_mask:0xf bank_mask:0xf
    v_cvt_pk_bf16_f32 v124, v128, v122
    s_nop 1
    v_mov_b32_dpp v125, v124 quad_perm:[2,2,2,2] row_mask:0xf bank_mask:0xf
    v_mov_b32_dpp v126, v124 row_shl:8 row_mask:0xf bank_mask:0xf
    s_nop 0
    v_mov_b32_dpp v127, v125 row_shl:8 row_mask:0xf bank_mask:0xf
    s_mov_b32 exec_lo, 0x00110011
    s_mov_b32 exec_hi, 0x00110011
    buffer_store_dwordx4 v[124:127], v12, s[72:75], s18 offen sc1
    s_mov_b64 exec, -1
    v_cvt_pk_bf16_f32 v128, v128, v128
    v_and_b32 v128, 0xffff0000, v128
    s_nop 1
L_r1skip:
    s_barrier
    s_mov_b32 s31, 0
L_pollr2:
    buffer_load_dwordx4 v[100:103], v8, s[76:79], 0 offen sc1
    buffer_load_dwordx4 v[104:107], v8, s[76:79], s19 offen sc1
    buffer_load_dwordx4 v[108:111], v8, s[76:79], s20 offen sc1
    s_waitcnt vmcnt(2)
    v_max3_u32 v11, v100, v101, v102
    v_mfma_f32_16x16x32_bf16 v[116:119], v[96:99], v[100:103], 0
    v_max_u32 v11, v11, v103
    s_waitcnt vmcnt(1)
    v_max3_u32 v11, v11, v104, v105
    v_mfma_f32_16x16x32_bf16 v[116:119], v[96:99], v[104:107], v[116:119]
    v_max3_u32 v11, v11, v106, v107
    s_waitcnt vmcnt(0)
    v_max3_u32 v11, v11, v108, v109
    v_mfma_f32_16x16x32_bf16 v[116:119], v[96:99], v[108:111], v[116:119]
    v_max3_u32 v11, v11, v110, v111
    v_cmp_eq_u32 vcc, -1, v11
    s_nop 0
    s_cmp_eq_u64 vcc, 0
    s_nop 3
    s_cbranch_scc1 Lpd_44
    s_add_u32 s31, s31, 1
    s_cmp_lt_u32 s31, 32768
    s_cbranch_scc1 L_pollr2
Lpd_44:
    v_add_f32_dpp v116, v116, v116 row_ror:8 row_mask:0xf bank_mask:0xf
    v_add_f32_dpp v117, v117, v117 row_ror:8 row_mask:0xf bank_mask:0xf
    v_add_f32_dpp v118, v118, v118 row_ror:8 row_mask:0xf bank_mask:0xf
    v_add_f32_dpp v119, v119, v119 row_ror:8 row_mask:0xf bank_mask:0xf
    s_mov_b64 exec, 0x00ff00ff
    ds_write_b128 v9, v[116:119]
    s_mov_b64 exec, -1
    s_waitcnt lgkmcnt(0)
    s_barrier
    s_cmp_lg_u32 s3, 0
    s_cbranch_scc1 L_fin
    ds_read2st64_b32 v[120:121], v10 offset0:0 offset1:1
    ds_read2st64_b32 v[122:123], v10 offset0:2 offset1:3
    s_waitcnt lgkmcnt(0)
    v_add_f32 v120, v120, v121
    v_add_f32 v122, v122, v123
    v_add_f32 v120, v120, v122
    v_cvt_pk_bf16_f32 v120, v120, v120
    v_and_b32 v120, 0xffff0000, v120
    v_add_f32 v128, v120, v128
    s_nop 1
    v_mov_b32_dpp v122, v128 quad_perm:[1,1,3,3] row_mask:0xf bank_mask:0xf
    v_cvt_pk_bf16_f32 v124, v128, v122
    s_nop 1
    v_mov_b32_dpp v125, v124 quad_perm:[2,2,2,2] row_mask:0xf bank_mask:0xf
    v_mov_b32_dpp v126, v124 row_shl:8 row_mask:0xf bank_mask:0xf
    s_nop 0
    v_mov_b32_dpp v127, v125 row_shl:8 row_mask:0xf bank_mask:0xf
    s_mov_b32 exec_lo, 0x00110011
    s_mov_b32 exec_hi, 0x00110011
    buffer_store_dwordx4 v[124:127], v12, s[68:71], s13 offen
    s_mov_b64 exec, -1
    s_cmp_lg_u32 s28, 0
    s_cbranch_scc1 L_fin
    v_mov_b32 v8, 0
    v_mov_b32 v9, s12
    s_mov_b64 exec, 1
    buffer_store_dword v9, v8, s[72:75], 0 offen sc1
    s_mov_b32 s93, 0
    s_mov_b64 exec, -1
    s_branch L_fin
L_ffn:
    s_mov_b32 s31, 0
Lw_45:
    ds_read_b32 v31, v5 offset:68
    s_waitcnt lgkmcnt(0)
    v_readfirstlane_b32 s86, v31
    s_nop 0
    s_cmp_ge_u32 s86, 4
    s_nop 2
    s_cbranch_scc1 Lwd_46
    s_add_u32 s31, s31, 1
    s_cmp_lt_u32 s31, 1048576
    s_cbranch_scc1 Lw_45
Lwd_46:
    s_barrier
    v_lshrrev_b32 v8, 1, v1
    v_and_b32 v9, 0x13, v8
    v_bfe_u32 v10, v8, 2, 1
    v_lshl_add_u32 v9, v10, 3, v9
    v_bfe_u32 v10, v8, 3, 1
    v_lshl_add_u32 v9, v10, 2, v9
    v_mul_u32_u24 v9, 2752, v9
    v_and_b32 v10, 1, v1
    v_lshl_add_u32 v9, v10, 4, v9
    s_mul_i32 s13, s3, 352256
    s_lshl_b32 s14, s27, 5
    s_add_u32 s13, s13, s14
    s_lshl_b32 s15, s3, 12
    s_add_u32 m0, s15, 98304
    s_nop 0
    buffer_load_dwordx4 v9, s[56:59], s13 offen lds
    s_add_u32 m0, s15, 114688
    s_nop 0
    buffer_load_dwordx4 v9, s[60:63], s13 offen lds
    s_add_u32 m0, s15, 99328
    s_add_u32 s13, s13, 88064
    buffer_load_dwordx4 v9, s[56:59], s13 offen lds
    s_add_u32 m0, s15, 115712
    s_nop 0
    buffer_load_dwordx4 v9, s[60:63], s13 offen lds
    s_add_u32 m0, s15, 100352
    s_add_u32 s13, s13, 88064
    buffer_load_dwordx4 v9, s[56:59], s13 offen lds
    s_add_u32 m0, s15, 116736
    s_nop 0
    buffer_load_dwordx4 v9, s[60:63], s13 offen lds
    s_add_u32 m0, s15, 101376
    s_add_u32 s13, s13, 88064
    buffer_load_dwordx4 v9, s[56:59], s13 offen lds
    s_add_u32 m0, s15, 117760
    s_nop 0
    buffer_load_dwordx4 v9, s[60:63], s13 offen lds
    s_and_b32 s13, s3, 1
    s_lshl_b32 s13, s13, 7
    v_xor_b32 v8, s13, v4
    s_lshl_b32 s13, s27, 14
    s_add_u32 s13, s13, s15
    s_add_u32 m0, s15, 131072
    s_nop 0
    buffer_load_dwordx4 v8, s[64:67], s13 offen offset:0 lds
    v_xor_b32 v10, 32, v8
    buffer_load_dwordx4 v10, s[64:67], s13 offen offset:1024 lds
    v_xor_b32 v10, 64, v8
    buffer_load_dwordx4 v10, s[64:67], s13 offen offset:2048 lds
    v_xor_b32 v10, 96, v8
    buffer_load_dwordx4 v10, s[64:67], s13 offen offset:3072 lds
    v_bfe_u32 v8, v1, 2, 3
    v_lshrrev_b32 v9, 1, v3
    v_lshl_add_u32 v8, v9, 4, v8
    v_and_b32 v10, 3, v1
    v_lshlrev_b32 v10, 3, v10
    v_lshl_add_u32 v11, v8, 5, v10
    s_add_u32 s13, s15, 98304
    v_add_u32 v11, s13, v11
    v_bfe_u32 v8, v1, 2, 4
    v_and_b32 v9, 7, v8
    v_lshl_add_u32 v9, v9, 5, v10
    v_lshl_add_u32 v9, v8, 10, v9
    s_lshl_b32 s13, s3, 8
    s_add_u32 s13, s13, 131072
    v_add_u32 v9, s13, v9
    v_lshlrev_b32 v20, 10, v2
    v_lshl_add_u32 v20, v3, 4, v20
    s_lshl_b32 s14, s3, 8
    s_add_u32 s14, s14, 360448
    s_mul_i32 s15, s3, 640
    s_add_u32 s15, s15, 153152
    v_lshlrev_b32 v12, 6, v3
    v_lshl_add_u32 v12, v2, 4, v12
    v_add_u32 v12, s15, v12
    v_and_b32 v10, 3, v2
    v_lshlrev_b32 v13, 4, v10
    v_lshl_add_u32 v13, v3, 6, v13
    v_lshrrev_b32 v8, 2, v2
    v_lshl_add_u32 v13, v8, 2, v13
    v_add_u32 v13, 153152, v13
    v_mul_u32_u24 v14, 20, v10
    v_add_u32 v14, 153664, v14
    v_lshlrev_b32 v15, 4, v10
    v_add_u32 v15, 153728, v15
    v_lshlrev_b32 v16, 4, v3
    v_lshl_add_u32 v16, v8, 2, v16
    v_add_u32 v16, 162624, v16
    s_mov_b32 s17, 98304
    v_mul_lo_u32 v19, v10, s17
    v_lshl_add_u32 v19, v3, 4, v19
    v_and_b32 v10, 1, v8
    v_lshl_add_u32 v19, v10, 6, v19
    v_lshrrev_b32 v10, 1, v8
    v_mul_u32_u24 v10, 12288, v10
    v_add_u32 v19, v19, v10
    s_mul_i32 s17, s3, 24576
    s_lshl_b32 s18, s27, 7
    s_add_u32 s17, s17, s18
    s_add_u32 s17, s17, 1048576
    s_add_u32 s18, s17, 12288
    v_mov_b32 v144, 0x3f803f80
    v_mov_b32 v145, 0x3f803f80
    v_mov_b32 v146, 0x3f803f80
    v_mov_b32 v147, 0x3f803f80
    v_mov_b32 v148, 0x3f803f80
    v_mov_b32 v149, 0x3f803f80
    v_mov_b32 v150, 0x3f803f80
    v_mov_b32 v151, 0x3f803f80
    v_mov_b32 v152, 0x3f803f80
    v_mov_b32 v153, 0x3f803f80
    v_mov_b32 v154, 0x3f803f80
    v_mov_b32 v155, 0x3f803f80
    v_mov_b32 v156, 0x3f803f80
    v_mov_b32 v157, 0x3f803f80
    v_mov_b32 v158, 0x3f803f80
    v_mov_b32 v159, 0x3f803f80
    s_waitcnt vmcnt(4)
    ds_read_b64_tr_b16 v[96:97], v11 offset:0
    ds_read_b64_tr_b16 v[98:99], v11 offset:256
    ds_read_b64_tr_b16 v[100:101], v11 offset:1024
    ds_read_b64_tr_b16 v[102:103], v11 offset:1280
    ds_read_b64_tr_b16 v[104:105], v11 offset:2048
    ds_read_b64_tr_b16 v[106:107], v11 offset:2304
    ds_read_b64_tr_b16 v[108:109], v11 offset:3072
    ds_read_b64_tr_b16 v[110:111], v11 offset:3328
    ds_read_b64_tr_b16 v[112:113], v11 offset:16384
    ds_read_b64_tr_b16 v[114:115], v11 offset:16640
    ds_read_b64_tr_b16 v[116:117], v11 offset:17408
    ds_read_b64_tr_b16 v[118:119], v11 offset:17664
    ds_read_b64_tr_b16 v[120:121], v11 offset:18432
    ds_read_b64_tr_b16 v[122:123], v11 offset:18688
    ds_read_b64_tr_b16 v[124:125], v11 offset:19456
    ds_read_b64_tr_b16 v[126:127], v11 offset:19712
    s_waitcnt lgkmcnt(0)
    v_mfma_f32_16x16x32_bf16 v[188:191], v[96:99], v[144:147], 0
    v_mfma_f32_16x16x32_bf16 v[188:191], v[100:103], v[144:147], v[188:191]
    v_mfma_f32_16x16x32_bf16 v[188:191], v[104:107], v[144:147], v[188:191]
    v_mfma_f32_16x16x32_bf16 v[188:191], v[108:111], v[144:147], v[188:191]
    v_mfma_f32_16x16x32_bf16 v[192:195], v[112:115], v[144:147], 0
    v_mfma_f32_16x16x32_bf16 v[192:195], v[116:119], v[144:147], v[192:195]
    v_mfma_f32_16x16x32_bf16 v[192:195], v[120:123], v[144:147], v[192:195]
    v_mfma_f32_16x16x32_bf16 v[192:195], v[124:127], v[144:147], v[192:195]
    s_lshl_b32 s13, s3, 7
    s_add_u32 s13, s13, 162624
    v_lshlrev_b32 v8, 4, v3
    v_add_u32 v8, s13, v8
    s_mov_b32 exec_lo, 0x00010001
    s_mov_b32 exec_hi, 0x00010001
    ds_write_b128 v8, v[188:191]
    s_nop 0
    ds_write_b128 v8, v[192:195] offset:64
    s_mov_b64 exec, -1
    s_waitcnt vmcnt(0) lgkmcnt(0)
    s_barrier
    ds_read_b64_tr_b16 v[128:129], v9
    v_xor_b32 v10, 32, v9
    ds_read_b64_tr_b16 v[130:131], v10
    v_xor_b32 v10, 64, v9
    ds_read_b64_tr_b16 v[132:133], v10
    v_xor_b32 v10, 96, v9
    ds_read_b64_tr_b16 v[134:135], v10
    v_xor_b32 v10, 128, v9
    ds_read_b64_tr_b16 v[136:137], v10
    v_xor_b32 v10, 160, v9
    ds_read_b64_tr_b16 v[138:139], v10
    v_xor_b32 v10, 192, v9
    ds_read_b64_tr_b16 v[140:141], v10
    v_xor_b32 v10, 224, v9
    ds_read_b64_tr_b16 v[142:143], v10
    ds_read2_b32 v[172:173], v16 offset0:0 offset1:16
    ds_read2_b32 v[174:175], v16 offset0:32 offset1:48
    ds_read2_b32 v[176:177], v16 offset0:64 offset1:80
    ds_read2_b32 v[178:179], v16 offset0:96 offset1:112
    s_waitcnt lgkmcnt(0)
    v_add_f32 v17, v172, v174
    v_add_f32 v18, v173, v175
    v_add_f32 v17, v17, v176
    v_add_f32 v18, v18, v177
    v_add_f32 v17, v17, v178
    v_add_f32 v18, v18, v179
    s_mov_b64 exec, s[84:85]
    s_mov_b32 s31, 0
L_pollh:
    buffer_load_dwordx4 v[144:147], v20, s[72:75], s14 offen offset:0 sc1
    buffer_load_dwordx4 v[148:151], v20, s[72:75], s14 offen offset:64 sc1
    buffer_load_dwordx4 v[152:155], v20, s[72:75], s14 offen offset:128 sc1
    buffer_load_dwordx4 v[156:159], v20, s[72:75], s14 offen offset:192 sc1
    s_waitcnt vmcnt(0)
    v_max3_u32 v11, v144, v145, v146
    v_max3_u32 v11, v11, v147, v148
    v_max3_u32 v11, v11, v149, v150
    v_max3_u32 v11, v11, v151, v152
    v_max3_u32 v11, v11, v153, v154
    v_max3_u32 v11, v11, v155, v156
    v_max3_u32 v11, v11, v157, v158
    v_max_u32 v11, v11, v159
    v_cmp_eq_u32 vcc, -1, v11
    s_nop 0
    s_cmp_eq_u64 vcc, 0
    s_nop 2
    s_cbranch_scc1 Lpd_47
    s_sleep 1
    s_add_u32 s31, s31, 1
    s_cmp_lt_u32 s31, 32768
    s_cbranch_scc1 L_pollh
Lpd_47:
    s_mov_b64 exec, -1
    v_mfma_f32_16x16x32_bf16 v[160:163], v[96:99], v[144:147], 0
    v_mfma_f32_16x16x32_bf16 v[164:167], v[112:115], v[144:147], 0
    v_mfma_f32_16x16x32_bf16 v[168:171], v[144:147], v[144:147], 0
    v_mfma_f32_16x16x32_bf16 v[160:163], v[100:103], v[148:151], v[160:163]
    v_mfma_f32_16x16x32_bf16 v[164:167], v[116:119], v[148:151], v[164:167]
    v_mfma_f32_16x16x32_bf16 v[168:171], v[148:151], v[148:151], v[168:171]
    v_mfma_f32_16x16x32_bf16 v[160:163], v[104:107], v[152:155], v[160:163]
    v_mfma_f32_16x16x32_bf16 v[164:167], v[120:123], v[152:155], v[164:167]
    v_mfma_f32_16x16x32_bf16 v[168:171], v[152:155], v[152:155], v[168:171]
    v_mfma_f32_16x16x32_bf16 v[160:163], v[108:111], v[156:159], v[160:163]
    v_mfma_f32_16x16x32_bf16 v[164:167], v[124:127], v[156:159], v[164:167]
    v_mfma_f32_16x16x32_bf16 v[168:171], v[156:159], v[156:159], v[168:171]
    s_mov_b64 exec, s[84:85]
    s_nop 4
    ds_write_b128 v12, v[160:163]
    ds_write_b128 v12, v[164:167] offset:256
    s_mov_b64 exec, 0x000f000f
    ds_write_b128 v12, v[168:171] offset:512
    s_mov_b64 exec, -1
    s_waitcnt lgkmcnt(0)
    s_barrier
    ds_read_b32 v180, v14 offset:0
    ds_read_b32 v184, v15 offset:0
    ds_read_b32 v181, v14 offset:640
    ds_read_b32 v185, v15 offset:640
    ds_read_b32 v182, v14 offset:1280
    ds_read_b32 v186, v15 offset:1280
    ds_read_b32 v183, v14 offset:1920
    ds_read_b32 v187, v15 offset:1920
    ds_read_b32 v172, v13 offset:0
    ds_read_b32 v173, v13 offset:256
    ds_read_b32 v174, v13 offset:640
    ds_read_b32 v175, v13 offset:896
    ds_read_b32 v176, v13 offset:1280
    ds_read_b32 v177, v13 offset:1536
    ds_read_b32 v178, v13 offset:1920
    ds_read_b32 v179, v13 offset:2176
    s_waitcnt lgkmcnt(8)
    v_add_f32 v24, v184, v185
    v_add_f32 v23, v180, v181
    v_add_f32 v24, v24, v186
    v_add_f32 v23, v23, v182
    v_add_f32 v24, v24, v187
    v_add_f32 v23, v23, v183
    v_mul_f32 v24, 0x3b000000, v24
    v_mul_f32 v23, 0x3b000000, v23
    v_fma_f32 v23, -v24, v24, v23
    v_max_f32 v23, 0, v23
    v_add_f32 v23, 0x3727c5ac, v23
    v_rsq_f32 v23, v23
    s_waitcnt lgkmcnt(0)
    v_add_f32 v21, v172, v174
    v_add_f32 v22, v173, v175
    v_add_f32 v21, v21, v176
    v_add_f32 v22, v22, v177
    v_add_f32 v21, v21, v178
    v_add_f32 v22, v22, v179
    v_fma_f32 v21, -v24, v17, v21
    v_fma_f32 v22, -v24, v18, v22
    v_mul_f32 v21, v21, v23
    v_mul_f32 v22, v22, v23
    v_mul_f32 v24, 0xbfb8aa3b, v21
    v_exp_f32 v24, v24
    v_mul_f32 v21, v21, v22
    v_add_f32 v24, 1.0, v24
    v_rcp_f32 v24, v24
    s_nop 0
    v_mul_f32 v21, v21, v24
    s_nop 1
    v_mov_b32_dpp v22, v21 row_shl:4 row_mask:0xf bank_mask:0xf
    v_cvt_pk_bf16_f32 v172, v21, v22
    s_nop 1
    v_mov_b32_dpp v173, v172 row_shl:8 row_mask:0xf bank_mask:0xf
    v_mov_b32_dpp v172, v172 row_shr:4 row_mask:0xf bank_mask:0x2
    s_nop 0
    v_mov_b32_dpp v173, v173 row_shr:4 row_mask:0xf bank_mask:0x2
    v_mov_b32_dpp v172, v172 row_shr:8 row_mask:0xf bank_mask:0xc
    s_nop 0
    v_mov_b32_dpp v173, v173 row_shr:8 row_mask:0xf bank_mask:0xc
    s_nop 1
    v_mfma_f32_16x16x16_bf16 v[188:191], v[128:129], v[172:173], 0
    v_mfma_f32_16x16x16_bf16 v[192:195], v[130:131], v[172:173], 0
    v_mfma_f32_16x16x16_bf16 v[196:199], v[132:133], v[172:173], 0
    v_mfma_f32_16x16x16_bf16 v[200:203], v[134:135], v[172:173], 0
    v_mfma_f32_16x16x16_bf16 v[204:207], v[136:137], v[172:173], 0
    v_mfma_f32_16x16x16_bf16 v[208:211], v[138:139], v[172:173], 0
    v_mfma_f32_16x16x16_bf16 v[212:215], v[140:141], v[172:173], 0
    v_mfma_f32_16x16x16_bf16 v[216:219], v[142:143], v[172:173], 0
    s_nop 0
    v_cvt_pk_bf16_f32 v220, v188, v189
    v_cvt_pk_bf16_f32 v221, v190, v191
    v_cvt_pk_bf16_f32 v222, v192, v193
    v_cvt_pk_bf16_f32 v223, v194, v195
    s_lshl_b64 exec, s[84:85], 4
    v_cvt_pk_bf16_f32 v220, v196, v197
    v_cvt_pk_bf16_f32 v221, v198, v199
    v_cvt_pk_bf16_f32 v222, v200, v201
    v_cvt_pk_bf16_f32 v223, v202, v203
    s_lshl_b64 exec, s[84:85], 8
    v_cvt_pk_bf16_f32 v220, v204, v205
    v_cvt_pk_bf16_f32 v221, v206, v207
    v_cvt_pk_bf16_f32 v222, v208, v209
    v_cvt_pk_bf16_f32 v223, v210, v211
    s_lshl_b64 exec, s[84:85], 12
    v_cvt_pk_bf16_f32 v220, v212, v213
    v_cvt_pk_bf16_f32 v221, v214, v215
    v_cvt_pk_bf16_f32 v222, v216, v217
    v_cvt_pk_bf16_f32 v223, v218, v219
    s_mov_b64 exec, -1
    buffer_store_dwordx4 v[220:223], v19, s[72:75], s17 offen sc1
    s_nop 1
    s_branch L_fin
L_wave45:
    s_lshl_b32 s16, s92, 16
    s_lshl_b32 s17, s11, 17
    s_add_u32 s17, s17, s16
    s_lshl_b32 s14, s92, 4
    v_add_u32 v19, s14, v5
    s_cmp_eq_u32 s10, 0
    s_nop 0
    s_cbranch_scc1 L_w45free
    s_setprio 3
    s_waitcnt vmcnt(0)
    v_lshlrev_b32 v40, 16, v32
    v_and_b32 v41, 0xffff0000, v32
    v_lshlrev_b32 v42, 16, v33
    v_and_b32 v43, 0xffff0000, v33
    v_lshlrev_b32 v44, 16, v34
    v_and_b32 v45, 0xffff0000, v34
    v_lshlrev_b32 v46, 16, v35
    v_and_b32 v47, 0xffff0000, v35
    v_add_f32 v52, v40, v41
    v_add_f32 v52, v52, v42
    v_add_f32 v52, v52, v43
    v_add_f32 v52, v52, v44
    v_add_f32 v52, v52, v45
    v_add_f32 v52, v52, v46
    v_add_f32 v52, v52, v47
    s_nop 1
    v_add_f32_dpp v52, v52, v52 row_shr:1 row_mask:0xf bank_mask:0xf bound_ctrl:0
    s_nop 1
    v_add_f32_dpp v52, v52, v52 row_shr:2 row_mask:0xf bank_mask:0xf bound_ctrl:0
    s_nop 1
    v_add_f32_dpp v52, v52, v52 row_shr:4 row_mask:0xf bank_mask:0xf bound_ctrl:0
    s_nop 1
    v_add_f32_dpp v52, v52, v52 row_shr:8 row_mask:0xf bank_mask:0xf bound_ctrl:0
    s_nop 1
    v_add_f32_dpp v52, v52, v52 row_bcast:15 row_mask:0xa bank_mask:0xf
    s_nop 1
    v_add_f32_dpp v52, v52, v52 row_bcast:31 row_mask:0xc bank_mask:0xf
    v_mov_b32 v55, 0x3b000000
    v_readlane_b32 s19, v52, 63
    s_nop 1
    v_mul_f32 v53, s19, v55
    v_sub_f32 v54, v40, v53
    v_mul_f32 v52, v54, v54
    v_sub_f32 v54, v41, v53
    v_fmac_f32 v52, v54, v54
    v_sub_f32 v54, v42, v53
    v_fmac_f32 v52, v54, v54
    v_sub_f32 v54, v43, v53
    v_fmac_f32 v52, v54, v54
    v_sub_f32 v54, v44, v53
    v_fmac_f32 v52, v54, v54
    v_sub_f32 v54, v45, v53
    v_fmac_f32 v52, v54, v54
    v_sub_f32 v54, v46, v53
    v_fmac_f32 v52, v54, v54
    v_sub_f32 v54, v47, v53
    v_fmac_f32 v52, v54, v54
    v_cvt_pk_bf16_f32 v53, v53, v53
    v_and_b32 v53, 0xffff0000, v53
    v_add_f32_dpp v52, v52, v52 row_shr:1 row_mask:0xf bank_mask:0xf bound_ctrl:0
    s_nop 1
    v_add_f32_dpp v52, v52, v52 row_shr:2 row_mask:0xf bank_mask:0xf bound_ctrl:0
    s_nop 1
    v_add_f32_dpp v52, v52, v52 row_shr:4 row_mask:0xf bank_mask:0xf bound_ctrl:0
    s_nop 1
    v_add_f32_dpp v52, v52, v52 row_shr:8 row_mask:0xf bank_mask:0xf bound_ctrl:0
    s_nop 1
    v_add_f32_dpp v52, v52, v52 row_bcast:15 row_mask:0xa bank_mask:0xf
    s_nop 1
    v_add_f32_dpp v52, v52, v52 row_bcast:31 row_mask:0xc bank_mask:0xf
    v_sub_f32 v40, v40, v53
    v_sub_f32 v41, v41, v53
    v_sub_f32 v42, v42, v53
    v_sub_f32 v43, v43, v53
    v_sub_f32 v44, v44, v53
    v_sub_f32 v45, v45, v53
    v_sub_f32 v46, v46, v53
    v_sub_f32 v47, v47, v53
    v_readlane_b32 s19, v52, 63
    v_cvt_pk_bf16_f32 v48, v40, v41
    v_cvt_pk_bf16_f32 v49, v42, v43
    v_cvt_pk_bf16_f32 v50, v44, v45
    v_cvt_pk_bf16_f32 v51, v46, v47
    v_mul_f32 v52, s19, v55
    v_cvt_pk_bf16_f32 v52, v52, v52
    v_and_b32 v52, 0xffff0000, v52
    v_add_f32 v52, 0x3727c5ac, v52
    v_cvt_pk_bf16_f32 v52, v52, v52
    v_and_b32 v52, 0xffff0000, v52
    v_sqrt_f32 v52, v52
    v_lshlrev_b32 v40, 16, v48
    v_and_b32 v41, 0xffff0000, v48
    v_lshlrev_b32 v42, 16, v49
    v_and_b32 v43, 0xffff0000, v49
    v_lshlrev_b32 v44, 16, v50
    v_and_b32 v45, 0xffff0000, v50
    v_lshlrev_b32 v46, 16, v51
    v_and_b32 v47, 0xffff0000, v51
    v_cvt_pk_bf16_f32 v52, v52, v52
    v_and_b32 v52, 0xffff0000, v52
    v_rcp_f32 v52, v52
    s_mul_i32 s19, s92, 1040
    s_add_u32 s19, s19, 147456
    v_add_u32 v55, s19, v4
    v_mul_f32 v40, v40, v52
    v_mul_f32 v41, v41, v52
    v_mul_f32 v42, v42, v52
    v_mul_f32 v43, v43, v52
    v_mul_f32 v44, v44, v52
    v_mul_f32 v45, v45, v52
    v_mul_f32 v46, v46, v52
    v_mul_f32 v47, v47, v52
    v_cvt_pk_bf16_f32 v48, v40, v41
    v_cvt_pk_bf16_f32 v49, v42, v43
    v_cvt_pk_bf16_f32 v50, v44, v45
    v_cvt_pk_bf16_f32 v51, v46, v47
    ds_write_b128 v55, v[48:51]
    s_mov_b64 exec, 1
    ds_add_u32 v5, v6 offset:0
    s_mov_b64 exec, -1
    s_setprio 0
    s_mov_b32 s31, 0
Lw_48:
    ds_read_b32 v31, v5 offset:28
    s_waitcnt lgkmcnt(0)
    v_readfirstlane_b32 s86, v31
    s_nop 0
    s_cmp_ge_u32 s86, 4
    s_nop 2
    s_cbranch_scc1 Lwd_49
    s_sleep 2
    s_add_u32 s31, s31, 1
    s_cmp_lt_u32 s31, 1048576
    s_cbranch_scc1 Lw_48
Lwd_49:
    s_add_u32 m0, s16, 0
    s_add_u32 s18, s17, 0
    v_xor_b32 v8, 0, v4
    buffer_load_dwordx4 v8, s[36:39], s18 offen offset:0 lds
    v_xor_b32 v9, 32, v4
    buffer_load_dwordx4 v9, s[36:39], s18 offen offset:1024 lds
    v_xor_b32 v8, 64, v4
    buffer_load_dwordx4 v8, s[36:39], s18 offen offset:2048 lds
    v_xor_b32 v9, 96, v4
    buffer_load_dwordx4 v9, s[36:39], s18 offen offset:3072 lds
    s_add_u32 m0, s16, 4096
    s_add_u32 s18, s17, 4096
    v_xor_b32 v8, 128, v4
    buffer_load_dwordx4 v8, s[36:39], s18 offen offset:0 lds
    v_xor_b32 v9, 160, v4
    buffer_load_dwordx4 v9, s[36:39], s18 offen offset:1024 lds
    v_xor_b32 v8, 192, v4
    buffer_load_dwordx4 v8, s[36:39], s18 offen offset:2048 lds
    v_xor_b32 v9, 224, v4
    buffer_load_dwordx4 v9, s[36:39], s18 offen offset:3072 lds
    s_add_u32 m0, s16, 8192
    s_add_u32 s18, s17, 8192
    v_xor_b32 v8, 144, v4
    buffer_load_dwordx4 v8, s[36:39], s18 offen offset:0 lds
    v_xor_b32 v9, 176, v4
    buffer_load_dwordx4 v9, s[36:39], s18 offen offset:1024 lds
    v_xor_b32 v8, 208, v4
    buffer_load_dwordx4 v8, s[36:39], s18 offen offset:2048 lds
    v_xor_b32 v9, 240, v4
    buffer_load_dwordx4 v9, s[36:39], s18 offen offset:3072 lds
    s_add_u32 m0, s16, 12288
    s_add_u32 s18, s17, 12288
    v_xor_b32 v8, 16, v4
    buffer_load_dwordx4 v8, s[36:39], s18 offen offset:0 lds
    v_xor_b32 v9, 48, v4
    buffer_load_dwordx4 v9, s[36:39], s18 offen offset:1024 lds
    v_xor_b32 v8, 80, v4
    s_waitcnt vmcnt(13)
    buffer_load_dwordx4 v8, s[36:39], s18 offen offset:2048 lds
    v_xor_b32 v9, 112, v4
    s_waitcnt vmcnt(13)
    buffer_load_dwordx4 v9, s[36:39], s18 offen offset:3072 lds
    s_add_u32 m0, s16, 32768
    s_add_u32 s18, s17, 32768
    v_xor_b32 v8, 0, v4
    s_waitcnt vmcnt(13)
    buffer_load_dwordx4 v8, s[36:39], s18 offen offset:0 lds
    v_xor_b32 v9, 32, v4
    s_waitcnt vmcnt(13)
    buffer_load_dwordx4 v9, s[36:39], s18 offen offset:1024 lds
    v_xor_b32 v8, 64, v4
    s_waitcnt vmcnt(13)
    buffer_load_dwordx4 v8, s[36:39], s18 offen offset:2048 lds
    v_xor_b32 v9, 96, v4
    s_waitcnt vmcnt(13)
    buffer_load_dwordx4 v9, s[36:39], s18 offen offset:3072 lds
    s_add_u32 m0, s16, 36864
    s_add_u32 s18, s17, 36864
    v_xor_b32 v8, 128, v4
    s_waitcnt vmcnt(13)
    buffer_load_dwordx4 v8, s[36:39], s18 offen offset:0 lds
    v_xor_b32 v9, 160, v4
    s_waitcnt vmcnt(13)
    buffer_load_dwordx4 v9, s[36:39], s18 offen offset:1024 lds
    v_xor_b32 v8, 192, v4
    s_waitcnt vmcnt(13)
    buffer_load_dwordx4 v8, s[36:39], s18 offen offset:2048 lds
    v_xor_b32 v9, 224, v4
    s_waitcnt vmcnt(13)
    buffer_load_dwordx4 v9, s[36:39], s18 offen offset:3072 lds
    s_add_u32 m0, s16, 40960
    s_add_u32 s18, s17, 40960
    v_xor_b32 v8, 144, v4
    s_waitcnt vmcnt(13)
    buffer_load_dwordx4 v8, s[36:39], s18 offen offset:0 lds
    v_xor_b32 v9, 176, v4
    s_waitcnt vmcnt(13)
    buffer_load_dwordx4 v9, s[36:39], s18 offen offset:1024 lds
    v_xor_b32 v8, 208, v4
    s_waitcnt vmcnt(13)
    buffer_load_dwordx4 v8, s[36:39], s18 offen offset:2048 lds
    v_xor_b32 v9, 240, v4
    s_waitcnt vmcnt(13)
    buffer_load_dwordx4 v9, s[36:39], s18 offen offset:3072 lds
    s_add_u32 m0, s16, 45056
    s_add_u32 s18, s17, 45056
    v_xor_b32 v8, 16, v4
    s_waitcnt vmcnt(13)
    buffer_load_dwordx4 v8, s[36:39], s18 offen offset:0 lds
    v_xor_b32 v9, 48, v4
    s_waitcnt vmcnt(13)
    s_mov_b64 exec, 1
    ds_add_u32 v19, v6 offset:32
    s_mov_b64 exec, -1
    buffer_load_dwordx4 v9, s[36:39], s18 offen offset:1024 lds
    v_xor_b32 v8, 80, v4
    s_waitcnt vmcnt(13)
    buffer_load_dwordx4 v8, s[36:39], s18 offen offset:2048 lds
    v_xor_b32 v9, 112, v4
    s_waitcnt vmcnt(13)
    buffer_load_dwordx4 v9, s[36:39], s18 offen offset:3072 lds
    s_add_u32 m0, s16, 16384
    s_add_u32 s18, s17, 16384
    v_xor_b32 v8, 0, v4
    s_waitcnt vmcnt(13)
    buffer_load_dwordx4 v8, s[36:39], s18 offen offset:0 lds
    v_xor_b32 v9, 32, v4
    s_waitcnt vmcnt(13)
    buffer_load_dwordx4 v9, s[36:39], s18 offen offset:1024 lds
    v_xor_b32 v8, 64, v4
    s_waitcnt vmcnt(13)
    buffer_load_dwordx4 v8, s[36:39], s18 offen offset:2048 lds
    v_xor_b32 v9, 96, v4
    s_waitcnt vmcnt(13)
    buffer_load_dwordx4 v9, s[36:39], s18 offen offset:3072 lds
    s_add_u32 m0, s16, 20480
    s_add_u32 s18, s17, 20480
    v_xor_b32 v8, 128, v4
    s_waitcnt vmcnt(13)
    buffer_load_dwordx4 v8, s[36:39], s18 offen offset:0 lds
    v_xor_b32 v9, 160, v4
    s_waitcnt vmcnt(13)
    buffer_load_dwordx4 v9, s[36:39], s18 offen offset:1024 lds
    v_xor_b32 v8, 192, v4
    s_waitcnt vmcnt(13)
    buffer_load_dwordx4 v8, s[36:39], s18 offen offset:2048 lds
    v_xor_b32 v9, 224, v4
    s_waitcnt vmcnt(13)
    buffer_load_dwordx4 v9, s[36:39], s18 offen offset:3072 lds
    s_add_u32 m0, s16, 24576
    s_add_u32 s18, s17, 24576
    v_xor_b32 v8, 144, v4
    s_waitcnt vmcnt(13)
    buffer_load_dwordx4 v8, s[36:39], s18 offen offset:0 lds
    v_xor_b32 v9, 176, v4
    s_waitcnt vmcnt(13)
    buffer_load_dwordx4 v9, s[36:39], s18 offen offset:1024 lds
    v_xor_b32 v8, 208, v4
    s_waitcnt vmcnt(13)
    buffer_load_dwordx4 v8, s[36:39], s18 offen offset:2048 lds
    v_xor_b32 v9, 240, v4
    s_waitcnt vmcnt(13)
    buffer_load_dwordx4 v9, s[36:39], s18 offen offset:3072 lds
    s_add_u32 m0, s16, 28672
    s_add_u32 s18, s17, 28672
    v_xor_b32 v8, 16, v4
    s_waitcnt vmcnt(13)
    buffer_load_dwordx4 v8, s[36:39], s18 offen offset:0 lds
    v_xor_b32 v9, 48, v4
    s_waitcnt vmcnt(13)
    s_mov_b64 exec, 1
    ds_add_u32 v19, v6 offset:40
    s_mov_b64 exec, -1
    buffer_load_dwordx4 v9, s[36:39], s18 offen offset:1024 lds
    v_xor_b32 v8, 80, v4
    s_waitcnt vmcnt(13)
    buffer_load_dwordx4 v8, s[36:39], s18 offen offset:2048 lds
    v_xor_b32 v9, 112, v4
    s_waitcnt vmcnt(13)
    buffer_load_dwordx4 v9, s[36:39], s18 offen offset:3072 lds
    s_mov_b64 exec, 1
    ds_add_u32 v5, v6 offset:24
    s_mov_b64 exec, -1
    s_add_u32 m0, s16, 49152
    s_add_u32 s18, s17, 49152
    v_xor_b32 v8, 0, v4
    s_waitcnt vmcnt(13)
    buffer_load_dwordx4 v8, s[36:39], s18 offen offset:0 lds
    v_xor_b32 v9, 32, v4
    s_waitcnt vmcnt(13)
    buffer_load_dwordx4 v9, s[36:39], s18 offen offset:1024 lds
    v_xor_b32 v8, 64, v4
    s_waitcnt vmcnt(13)
    buffer_load_dwordx4 v8, s[36:39], s18 offen offset:2048 lds
    v_xor_b32 v9, 96, v4
    s_waitcnt vmcnt(13)
    buffer_load_dwordx4 v9, s[36:39], s18 offen offset:3072 lds
    s_add_u32 m0, s16, 53248
    s_add_u32 s18, s17, 53248
    v_xor_b32 v8, 128, v4
    s_waitcnt vmcnt(13)
    buffer_load_dwordx4 v8, s[36:39], s18 offen offset:0 lds
    v_xor_b32 v9, 160, v4
    s_waitcnt vmcnt(13)
    buffer_load_dwordx4 v9, s[36:39], s18 offen offset:1024 lds
    v_xor_b32 v8, 192, v4
    s_waitcnt vmcnt(13)
    buffer_load_dwordx4 v8, s[36:39], s18 offen offset:2048 lds
    v_xor_b32 v9, 224, v4
    s_waitcnt vmcnt(13)
    buffer_load_dwordx4 v9, s[36:39], s18 offen offset:3072 lds
    s_add_u32 m0, s16, 57344
    s_add_u32 s18, s17, 57344
    v_xor_b32 v8, 144, v4
    s_waitcnt vmcnt(13)
    buffer_load_dwordx4 v8, s[36:39], s18 offen offset:0 lds
    v_xor_b32 v9, 176, v4
    s_waitcnt vmcnt(13)
    buffer_load_dwordx4 v9, s[36:39], s18 offen offset:1024 lds
    v_xor_b32 v8, 208, v4
    s_waitcnt vmcnt(13)
    buffer_load_dwordx4 v8, s[36:39], s18 offen offset:2048 lds
    v_xor_b32 v9, 240, v4
    s_waitcnt vmcnt(13)
    buffer_load_dwordx4 v9, s[36:39], s18 offen offset:3072 lds
    s_add_u32 m0, s16, 61440
    s_add_u32 s18, s17, 61440
    v_xor_b32 v8, 16, v4
    s_waitcnt vmcnt(13)
    buffer_load_dwordx4 v8, s[36:39], s18 offen offset:0 lds
    v_xor_b32 v9, 48, v4
    s_waitcnt vmcnt(13)
    s_mov_b64 exec, 1
    ds_add_u32 v19, v6 offset:36
    s_mov_b64 exec, -1
    buffer_load_dwordx4 v9, s[36:39], s18 offen offset:1024 lds
    v_xor_b32 v8, 80, v4
    s_waitcnt vmcnt(13)
    buffer_load_dwordx4 v8, s[36:39], s18 offen offset:2048 lds
    v_xor_b32 v9, 112, v4
    s_waitcnt vmcnt(13)
    buffer_load_dwordx4 v9, s[36:39], s18 offen offset:3072 lds
    s_mov_b64 exec, 1
    ds_add_u32 v5, v6 offset:84
    s_mov_b64 exec, -1
    s_waitcnt vmcnt(0)
    s_mov_b64 exec, 1
    ds_add_u32 v19, v6 offset:44
    s_mov_b64 exec, -1
    s_branch L_w45pf
L_w45free:
    s_mov_b32 s31, 0
Lw_50:
    ds_read_b32 v31, v5 offset:28
    s_waitcnt lgkmcnt(0)
    v_readfirstlane_b32 s86, v31
    s_nop 0
    s_cmp_ge_u32 s86, 4
    s_nop 2
    s_cbranch_scc1 Lwd_51
    s_sleep 1
    s_add_u32 s31, s31, 1
    s_cmp_lt_u32 s31, 1048576
    s_cbranch_scc1 Lw_50
Lwd_51:
    s_add_u32 m0, s16, 0
    s_add_u32 s18, s17, 0
    v_xor_b32 v8, 0, v4
    buffer_load_dwordx4 v8, s[36:39], s18 offen offset:0 lds
    v_xor_b32 v9, 32, v4
    buffer_load_dwordx4 v9, s[36:39], s18 offen offset:1024 lds
    v_xor_b32 v8, 64, v4
    buffer_load_dwordx4 v8, s[36:39], s18 offen offset:2048 lds
    v_xor_b32 v9, 96, v4
    buffer_load_dwordx4 v9, s[36:39], s18 offen offset:3072 lds
    s_add_u32 m0, s16, 4096
    s_add_u32 s18, s17, 4096
    v_xor_b32 v8, 128, v4
    buffer_load_dwordx4 v8, s[36:39], s18 offen offset:0 lds
    v_xor_b32 v9, 160, v4
    buffer_load_dwordx4 v9, s[36:39], s18 offen offset:1024 lds
    v_xor_b32 v8, 192, v4
    buffer_load_dwordx4 v8, s[36:39], s18 offen offset:2048 lds
    v_xor_b32 v9, 224, v4
    buffer_load_dwordx4 v9, s[36:39], s18 offen offset:3072 lds
    s_add_u32 m0, s16, 8192
    s_add_u32 s18, s17, 8192
    v_xor_b32 v8, 144, v4
    buffer_load_dwordx4 v8, s[36:39], s18 offen offset:0 lds
    v_xor_b32 v9, 176, v4
    buffer_load_dwordx4 v9, s[36:39], s18 offen offset:1024 lds
    v_xor_b32 v8, 208, v4
    buffer_load_dwordx4 v8, s[36:39], s18 offen offset:2048 lds
    v_xor_b32 v9, 240, v4
    buffer_load_dwordx4 v9, s[36:39], s18 offen offset:3072 lds
    s_add_u32 m0, s16, 12288
    s_add_u32 s18, s17, 12288
    v_xor_b32 v8, 16, v4
    buffer_load_dwordx4 v8, s[36:39], s18 offen offset:0 lds
    v_xor_b32 v9, 48, v4
    buffer_load_dwordx4 v9, s[36:39], s18 offen offset:1024 lds
    v_xor_b32 v8, 80, v4
    buffer_load_dwordx4 v8, s[36:39], s18 offen offset:2048 lds
    v_xor_b32 v9, 112, v4
    buffer_load_dwordx4 v9, s[36:39], s18 offen offset:3072 lds
    s_add_u32 m0, s16, 32768
    s_add_u32 s18, s17, 32768
    v_xor_b32 v8, 0, v4
    buffer_load_dwordx4 v8, s[36:39], s18 offen offset:0 lds
    v_xor_b32 v9, 32, v4
    buffer_load_dwordx4 v9, s[36:39], s18 offen offset:1024 lds
    v_xor_b32 v8, 64, v4
    buffer_load_dwordx4 v8, s[36:39], s18 offen offset:2048 lds
    v_xor_b32 v9, 96, v4
    buffer_load_dwordx4 v9, s[36:39], s18 offen offset:3072 lds
    s_add_u32 m0, s16, 36864
    s_add_u32 s18, s17, 36864
    v_xor_b32 v8, 128, v4
    s_waitcnt vmcnt(19)
    buffer_load_dwordx4 v8, s[36:39], s18 offen offset:0 lds
    v_xor_b32 v9, 160, v4
    s_waitcnt vmcnt(19)
    buffer_load_dwordx4 v9, s[36:39], s18 offen offset:1024 lds
    v_xor_b32 v8, 192, v4
    s_waitcnt vmcnt(19)
    buffer_load_dwordx4 v8, s[36:39], s18 offen offset:2048 lds
    v_xor_b32 v9, 224, v4
    s_waitcnt vmcnt(19)
    buffer_load_dwordx4 v9, s[36:39], s18 offen offset:3072 lds
    s_add_u32 m0, s16, 40960
    s_add_u32 s18, s17, 40960
    v_xor_b32 v8, 144, v4
    s_waitcnt vmcnt(19)
    buffer_load_dwordx4 v8, s[36:39], s18 offen offset:0 lds
    v_xor_b32 v9, 176, v4
    s_waitcnt vmcnt(19)
    buffer_load_dwordx4 v9, s[36:39], s18 offen offset:1024 lds
    v_xor_b32 v8, 208, v4
    s_waitcnt vmcnt(19)
    buffer_load_dwordx4 v8, s[36:39], s18 offen offset:2048 lds
    v_xor_b32 v9, 240, v4
    s_waitcnt vmcnt(19)
    buffer_load_dwordx4 v9, s[36:39], s18 offen offset:3072 lds
    s_add_u32 m0, s16, 45056
    s_add_u32 s18, s17, 45056
    v_xor_b32 v8, 16, v4
    s_waitcnt vmcnt(19)
    buffer_load_dwordx4 v8, s[36:39], s18 offen offset:0 lds
    v_xor_b32 v9, 48, v4
    s_waitcnt vmcnt(19)
    buffer_load_dwordx4 v9, s[36:39], s18 offen offset:1024 lds
    v_xor_b32 v8, 80, v4
    s_waitcnt vmcnt(19)
    buffer_load_dwordx4 v8, s[36:39], s18 offen offset:2048 lds
    v_xor_b32 v9, 112, v4
    s_waitcnt vmcnt(19)
    buffer_load_dwordx4 v9, s[36:39], s18 offen offset:3072 lds
    s_add_u32 m0, s16, 16384
    s_add_u32 s18, s17, 16384
    v_xor_b32 v8, 0, v4
    s_waitcnt vmcnt(19)
    buffer_load_dwordx4 v8, s[36:39], s18 offen offset:0 lds
    v_xor_b32 v9, 32, v4
    s_waitcnt vmcnt(19)
    buffer_load_dwordx4 v9, s[36:39], s18 offen offset:1024 lds
    v_xor_b32 v8, 64, v4
    s_waitcnt vmcnt(19)
    buffer_load_dwordx4 v8, s[36:39], s18 offen offset:2048 lds
    v_xor_b32 v9, 96, v4
    s_waitcnt vmcnt(19)
    s_mov_b64 exec, 1
    ds_add_u32 v19, v6 offset:32
    s_mov_b64 exec, -1
    buffer_load_dwordx4 v9, s[36:39], s18 offen offset:3072 lds
    s_add_u32 m0, s16, 20480
    s_add_u32 s18, s17, 20480
    v_xor_b32 v8, 128, v4
    s_waitcnt vmcnt(19)
    buffer_load_dwordx4 v8, s[36:39], s18 offen offset:0 lds
    v_xor_b32 v9, 160, v4
    s_waitcnt vmcnt(19)
    buffer_load_dwordx4 v9, s[36:39], s18 offen offset:1024 lds
    v_xor_b32 v8, 192, v4
    s_waitcnt vmcnt(19)
    buffer_load_dwordx4 v8, s[36:39], s18 offen offset:2048 lds
    v_xor_b32 v9, 224, v4
    s_waitcnt vmcnt(19)
    buffer_load_dwordx4 v9, s[36:39], s18 offen offset:3072 lds
    s_add_u32 m0, s16, 24576
    s_add_u32 s18, s17, 24576
    v_xor_b32 v8, 144, v4
    s_waitcnt vmcnt(19)
    buffer_load_dwordx4 v8, s[36:39], s18 offen offset:0 lds
    v_xor_b32 v9, 176, v4
    s_waitcnt vmcnt(19)
    buffer_load_dwordx4 v9, s[36:39], s18 offen offset:1024 lds
    v_xor_b32 v8, 208, v4
    s_waitcnt vmcnt(19)
    buffer_load_dwordx4 v8, s[36:39], s18 offen offset:2048 lds
    v_xor_b32 v9, 240, v4
    s_waitcnt vmcnt(19)
    buffer_load_dwordx4 v9, s[36:39], s18 offen offset:3072 lds
    s_add_u32 m0, s16, 28672
    s_add_u32 s18, s17, 28672
    v_xor_b32 v8, 16, v4
    s_waitcnt vmcnt(19)
    buffer_load_dwordx4 v8, s[36:39], s18 offen offset:0 lds
    v_xor_b32 v9, 48, v4
    s_waitcnt vmcnt(19)
    buffer_load_dwordx4 v9, s[36:39], s18 offen offset:1024 lds
    v_xor_b32 v8, 80, v4
    s_waitcnt vmcnt(19)
    buffer_load_dwordx4 v8, s[36:39], s18 offen offset:2048 lds
    v_xor_b32 v9, 112, v4
    s_waitcnt vmcnt(19)
    buffer_load_dwordx4 v9, s[36:39], s18 offen offset:3072 lds
    s_add_u32 m0, s16, 49152
    s_add_u32 s18, s17, 49152
    v_xor_b32 v8, 0, v4
    s_waitcnt vmcnt(19)
    buffer_load_dwordx4 v8, s[36:39], s18 offen offset:0 lds
    v_xor_b32 v9, 32, v4
    s_waitcnt vmcnt(19)
    buffer_load_dwordx4 v9, s[36:39], s18 offen offset:1024 lds
    v_xor_b32 v8, 64, v4
    s_waitcnt vmcnt(19)
    buffer_load_dwordx4 v8, s[36:39], s18 offen offset:2048 lds
    v_xor_b32 v9, 96, v4
    s_waitcnt vmcnt(19)
    s_mov_b64 exec, 1
    ds_add_u32 v19, v6 offset:40
    s_mov_b64 exec, -1
    buffer_load_dwordx4 v9, s[36:39], s18 offen offset:3072 lds
    s_add_u32 m0, s16, 53248
    s_add_u32 s18, s17, 53248
    v_xor_b32 v8, 128, v4
    s_waitcnt vmcnt(19)
    buffer_load_dwordx4 v8, s[36:39], s18 offen offset:0 lds
    v_xor_b32 v9, 160, v4
    s_waitcnt vmcnt(19)
    buffer_load_dwordx4 v9, s[36:39], s18 offen offset:1024 lds
    v_xor_b32 v8, 192, v4
    s_waitcnt vmcnt(19)
    buffer_load_dwordx4 v8, s[36:39], s18 offen offset:2048 lds
    v_xor_b32 v9, 224, v4
    s_waitcnt vmcnt(19)
    buffer_load_dwordx4 v9, s[36:39], s18 offen offset:3072 lds
    s_add_u32 m0, s16, 57344
    s_add_u32 s18, s17, 57344
    v_xor_b32 v8, 144, v4
    s_waitcnt vmcnt(19)
    buffer_load_dwordx4 v8, s[36:39], s18 offen offset:0 lds
    v_xor_b32 v9, 176, v4
    s_waitcnt vmcnt(19)
    buffer_load_dwordx4 v9, s[36:39], s18 offen offset:1024 lds
    v_xor_b32 v8, 208, v4
    s_waitcnt vmcnt(19)
    buffer_load_dwordx4 v8, s[36:39], s18 offen offset:2048 lds
    v_xor_b32 v9, 240, v4
    s_waitcnt vmcnt(19)
    buffer_load_dwordx4 v9, s[36:39], s18 offen offset:3072 lds
    s_add_u32 m0, s16, 61440
    s_add_u32 s18, s17, 61440
    v_xor_b32 v8, 16, v4
    s_waitcnt vmcnt(19)
    buffer_load_dwordx4 v8, s[36:39], s18 offen offset:0 lds
    v_xor_b32 v9, 48, v4
    s_waitcnt vmcnt(19)
    buffer_load_dwordx4 v9, s[36:39], s18 offen offset:1024 lds
    v_xor_b32 v8, 80, v4
    s_waitcnt vmcnt(19)
    buffer_load_dwordx4 v8, s[36:39], s18 offen offset:2048 lds
    v_xor_b32 v9, 112, v4
    s_waitcnt vmcnt(19)
    buffer_load_dwordx4 v9, s[36:39], s18 offen offset:3072 lds
    s_mov_b64 exec, 1
    ds_add_u32 v5, v6 offset:84
    s_mov_b64 exec, -1
    s_waitcnt vmcnt(16)
    s_mov_b64 exec, 1
    ds_add_u32 v19, v6 offset:36
    s_mov_b64 exec, -1
    s_waitcnt vmcnt(0)
    s_mov_b64 exec, 1
    ds_add_u32 v5, v6 offset:24
    s_mov_b64 exec, -1
    s_waitcnt vmcnt(0)
    s_mov_b64 exec, 1
    ds_add_u32 v19, v6 offset:44
    s_mov_b64 exec, -1
L_w45pf:
    v_lshrrev_b32 v8, 2, v1
    v_mul_u32_u24 v8, 2752, v8
    v_and_b32 v9, 3, v1
    v_lshlrev_b32 v9, 7, v9
    v_min_u32 v9, 348, v9
    v_add_u32 v8, v8, v9
    s_mul_i32 s14, s5, 44032
    s_mul_i32 s15, s4, 352
    s_add_u32 s14, s14, s15
    v_min_u32 v9, 21, v1
    v_lshlrev_b32 v9, 7, v9
    s_mul_i32 s15, s4, 180224
    s_lshl_b32 s16, s5, 1
    s_add_u32 s16, s16, s92
    s_mul_i32 s16, s16, 2816
    s_add_u32 s15, s15, s16
    s_mov_b32 s22, s14
    s_mov_b32 s23, s15
    s_branch L_phaseC
L_wave67:
    s_and_b32 s13, s3, 1
    s_cmp_eq_u32 s10, 0
    s_cbranch_scc1 L_noLN
    s_setprio 3
    s_waitcnt vmcnt(0)
    v_lshlrev_b32 v40, 16, v32
    v_and_b32 v41, 0xffff0000, v32
    v_lshlrev_b32 v42, 16, v33
    v_and_b32 v43, 0xffff0000, v33
    v_lshlrev_b32 v44, 16, v34
    v_and_b32 v45, 0xffff0000, v34
    v_lshlrev_b32 v46, 16, v35
    v_and_b32 v47, 0xffff0000, v35
    v_add_f32 v52, v40, v41
    v_add_f32 v52, v52, v42
    v_add_f32 v52, v52, v43
    v_add_f32 v52, v52, v44
    v_add_f32 v52, v52, v45
    v_add_f32 v52, v52, v46
    v_add_f32 v52, v52, v47
    s_nop 1
    v_add_f32_dpp v52, v52, v52 row_shr:1 row_mask:0xf bank_mask:0xf bound_ctrl:0
    s_nop 1
    v_add_f32_dpp v52, v52, v52 row_shr:2 row_mask:0xf bank_mask:0xf bound_ctrl:0
    s_nop 1
    v_add_f32_dpp v52, v52, v52 row_shr:4 row_mask:0xf bank_mask:0xf bound_ctrl:0
    s_nop 1
    v_add_f32_dpp v52, v52, v52 row_shr:8 row_mask:0xf bank_mask:0xf bound_ctrl:0
    s_nop 1
    v_add_f32_dpp v52, v52, v52 row_bcast:15 row_mask:0xa bank_mask:0xf
    s_nop 1
    v_add_f32_dpp v52, v52, v52 row_bcast:31 row_mask:0xc bank_mask:0xf
    v_mov_b32 v55, 0x3b000000
    v_readlane_b32 s19, v52, 63
    s_nop 1
    v_mul_f32 v53, s19, v55
    v_sub_f32 v54, v40, v53
    v_mul_f32 v52, v54, v54
    v_sub_f32 v54, v41, v53
    v_fmac_f32 v52, v54, v54
    v_sub_f32 v54, v42, v53
    v_fmac_f32 v52, v54, v54
    v_sub_f32 v54, v43, v53
    v_fmac_f32 v52, v54, v54
    v_sub_f32 v54, v44, v53
    v_fmac_f32 v52, v54, v54
    v_sub_f32 v54, v45, v53
    v_fmac_f32 v52, v54, v54
    v_sub_f32 v54, v46, v53
    v_fmac_f32 v52, v54, v54
    v_sub_f32 v54, v47, v53
    v_fmac_f32 v52, v54, v54
    v_cvt_pk_bf16_f32 v53, v53, v53
    v_and_b32 v53, 0xffff0000, v53
    v_add_f32_dpp v52, v52, v52 row_shr:1 row_mask:0xf bank_mask:0xf bound_ctrl:0
    s_nop 1
    v_add_f32_dpp v52, v52, v52 row_shr:2 row_mask:0xf bank_mask:0xf bound_ctrl:0
    s_nop 1
    v_add_f32_dpp v52, v52, v52 row_shr:4 row_mask:0xf bank_mask:0xf bound_ctrl:0
    s_nop 1
    v_add_f32_dpp v52, v52, v52 row_shr:8 row_mask:0xf bank_mask:0xf bound_ctrl:0
    s_nop 1
    v_add_f32_dpp v52, v52, v52 row_bcast:15 row_mask:0xa bank_mask:0xf
    s_nop 1
    v_add_f32_dpp v52, v52, v52 row_bcast:31 row_mask:0xc bank_mask:0xf
    v_sub_f32 v40, v40, v53
    v_sub_f32 v41, v41, v53
    v_sub_f32 v42, v42, v53
    v_sub_f32 v43, v43, v53
    v_sub_f32 v44, v44, v53
    v_sub_f32 v45, v45, v53
    v_sub_f32 v46, v46, v53
    v_sub_f32 v47, v47, v53
    v_readlane_b32 s19, v52, 63
    v_cvt_pk_bf16_f32 v48, v40, v41
    v_cvt_pk_bf16_f32 v49, v42, v43
    v_cvt_pk_bf16_f32 v50, v44, v45
    v_cvt_pk_bf16_f32 v51, v46, v47
    v_mul_f32 v52, s19, v55
    v_cvt_pk_bf16_f32 v52, v52, v52
    v_and_b32 v52, 0xffff0000, v52
    v_add_f32 v52, 0x3727c5ac, v52
    v_cvt_pk_bf16_f32 v52, v52, v52
    v_and_b32 v52, 0xffff0000, v52
    v_sqrt_f32 v52, v52
    v_lshlrev_b32 v40, 16, v48
    v_and_b32 v41, 0xffff0000, v48
    v_lshlrev_b32 v42, 16, v49
    v_and_b32 v43, 0xffff0000, v49
    v_lshlrev_b32 v44, 16, v50
    v_and_b32 v45, 0xffff0000, v50
    v_lshlrev_b32 v46, 16, v51
    v_and_b32 v47, 0xffff0000, v51
    v_cvt_pk_bf16_f32 v52, v52, v52
    v_and_b32 v52, 0xffff0000, v52
    v_rcp_f32 v52, v52
    s_mul_i32 s19, s92, 1040
    s_add_u32 s19, s19, 147456
    v_add_u32 v55, s19, v4
    v_mul_f32 v40, v40, v52
    v_mul_f32 v41, v41, v52
    v_mul_f32 v42, v42, v52
    v_mul_f32 v43, v43, v52
    v_mul_f32 v44, v44, v52
    v_mul_f32 v45, v45, v52
    v_mul_f32 v46, v46, v52
    v_mul_f32 v47, v47, v52
    v_cvt_pk_bf16_f32 v48, v40, v41
    v_cvt_pk_bf16_f32 v49, v42, v43
    v_cvt_pk_bf16_f32 v50, v44, v45
    v_cvt_pk_bf16_f32 v51, v46, v47
    ds_write_b128 v55, v[48:51]
    s_mov_b64 exec, 1
    ds_add_u32 v5, v6 offset:0
    s_mov_b64 exec, -1
    s_branch L_w67rest
L_noLN:
L_w67rest:
    v_mov_b32 v12, -1
    v_mov_b32 v13, -1
    v_mov_b32 v14, -1
    v_mov_b32 v15, -1
    v_and_b32 v16, 7, v1
    v_lshlrev_b32 v16, 4, v16
    v_bfe_u32 v17, v1, 3, 1
    v_lshl_add_u32 v18, v17, 14, v16
    v_lshl_add_u32 v18, v3, 17, v18
    s_lshl_b32 s14, s9, 1
    s_add_u32 s14, s14, s13
    s_lshl_b32 s14, s14, 15
    s_lshl_b32 s15, s6, 2
    s_add_u32 s15, s15, s8
    s_lshl_b32 s15, s15, 7
    s_add_u32 s14, s14, s15
    s_add_u32 s14, s14, 524288
    buffer_store_dwordx4 v[12:15], v18, s[72:75], s14 offen sc1
    s_cmp_eq_u32 s30, 0
    s_nop 0
    s_cbranch_scc1 L_noclrH
    s_cmp_lg_u32 s3, 7
    s_cbranch_scc1 L_noclrH
    s_lshl_b32 s14, s28, 7
    s_add_u32 s14, s14, 360448
    s_mov_b64 exec, 0xff
    buffer_store_dwordx4 v[12:15], v4, s[72:75], s14 offen sc1
    s_mov_b64 exec, -1
    s_nop 0
L_noclrH:
    s_cmp_eq_u32 s29, 0
    s_cbranch_scc1 L_noclrF
    v_mul_u32_u24 v18, 12288, v17
    v_add_u32 v18, v18, v16
    s_mov_b32 s14, 98304
    v_mul_lo_u32 v17, v3, s14
    v_add_u32 v18, v18, v17
    s_mul_i32 s14, s13, 49152
    s_lshl_b32 s15, s27, 7
    s_add_u32 s14, s14, s15
    s_add_u32 s14, s14, 1048576
    s_add_u32 s15, s14, 24576
    buffer_store_dwordx4 v[12:15], v18, s[72:75], s14 offen sc1
    buffer_store_dwordx4 v[12:15], v18, s[72:75], s15 offen sc1
    s_nop 1
L_noclrF:
    s_waitcnt vmcnt(0)
    s_mov_b64 exec, 1
    ds_add_u32 v5, v6 offset:4
    s_mov_b64 exec, -1
    s_setprio 0
    v_lshlrev_b32 v12, 13, v3
    v_lshl_add_u32 v12, v2, 4, v12
    s_lshl_b32 s14, s8, 7
    s_lshl_b32 s15, s13, 6
    s_add_u32 s14, s14, s15
    s_lshl_b32 s14, s14, 13
    s_lshl_b32 s15, s6, 8
    s_add_u32 s14, s14, s15
    v_lshrrev_b32 v13, 5, v1
    v_lshlrev_b32 v13, 10, v13
    v_and_b32 v14, 31, v1
    v_lshl_add_u32 v13, v14, 4, v13
    s_lshl_b32 s15, s6, 17
    s_lshl_b32 s16, s13, 16
    s_add_u32 s15, s15, s16
    s_lshl_b32 s16, s9, 9
    s_add_u32 s15, s15, s16
    s_waitcnt vmcnt(0)
    s_mov_b32 s31, 0
Lw_52:
    ds_read_b32 v31, v5 offset:84
    s_waitcnt lgkmcnt(0)
    v_readfirstlane_b32 s86, v31
    s_nop 0
    s_cmp_ge_u32 s86, 6
    s_nop 2
    s_cbranch_scc1 Lwd_53
    s_sleep 2
    s_add_u32 s31, s31, 1
    s_cmp_lt_u32 s31, 1048576
    s_cbranch_scc1 Lw_52
Lwd_53:
    buffer_load_dwordx4 v[32:35], v12, s[48:51], s14 offen
    s_add_u32 s14, s14, 32768
    buffer_load_dwordx4 v[36:39], v12, s[48:51], s14 offen
    s_add_u32 s14, s14, 32768
    buffer_load_dwordx4 v[40:43], v12, s[48:51], s14 offen
    s_add_u32 s14, s14, 32768
    buffer_load_dwordx4 v[44:47], v12, s[48:51], s14 offen
    s_add_u32 s14, s14, 32768
    buffer_load_dwordx4 v[48:51], v12, s[48:51], s14 offen
    s_add_u32 s14, s14, 32768
    buffer_load_dwordx4 v[52:55], v12, s[48:51], s14 offen
    s_add_u32 s14, s14, 32768
    buffer_load_dwordx4 v[56:59], v12, s[48:51], s14 offen
    s_add_u32 s14, s14, 32768
    buffer_load_dwordx4 v[60:63], v12, s[48:51], s14 offen
    s_add_u32 s14, s14, 32768
    buffer_load_dwordx4 v[64:67], v12, s[48:51], s14 offen
    s_add_u32 s14, s14, 32768
    buffer_load_dwordx4 v[68:71], v12, s[48:51], s14 offen
    s_add_u32 s14, s14, 32768
    buffer_load_dwordx4 v[72:75], v12, s[48:51], s14 offen
    s_add_u32 s14, s14, 32768
    buffer_load_dwordx4 v[76:79], v12, s[48:51], s14 offen
    s_waitcnt vmcnt(11)
    s_add_u32 s14, s14, 32768
    buffer_load_dwordx4 v[80:83], v12, s[48:51], s14 offen
    s_waitcnt vmcnt(11)
    s_add_u32 s14, s14, 32768
    buffer_load_dwordx4 v[84:87], v12, s[48:51], s14 offen
    s_waitcnt vmcnt(11)
    s_add_u32 s14, s14, 32768
    buffer_load_dwordx4 v[88:91], v12, s[48:51], s14 offen
    s_waitcnt vmcnt(11)
    s_add_u32 s14, s14, 32768
    buffer_load_dwordx4 v[92:95], v12, s[48:51], s14 offen
    s_waitcnt vmcnt(11)
    buffer_load_dwordx4 v[96:99], v13, s[52:55], s15 offen offset:0
    s_waitcnt vmcnt(11)
    buffer_load_dwordx4 v[100:103], v13, s[52:55], s15 offen offset:2048
    s_waitcnt vmcnt(11)
    s_add_u32 s15, s15, 4096
    buffer_load_dwordx4 v[104:107], v13, s[52:55], s15 offen offset:0
    s_waitcnt vmcnt(11)
    buffer_load_dwordx4 v[108:111], v13, s[52:55], s15 offen offset:2048
    s_waitcnt vmcnt(11)
    s_add_u32 s15, s15, 4096
    buffer_load_dwordx4 v[112:115], v13, s[52:55], s15 offen offset:0
    s_waitcnt vmcnt(11)
    buffer_load_dwordx4 v[116:119], v13, s[52:55], s15 offen offset:2048
    s_waitcnt vmcnt(11)
    s_add_u32 s15, s15, 4096
    buffer_load_dwordx4 v[120:123], v13, s[52:55], s15 offen offset:0
    s_waitcnt vmcnt(11)
    buffer_load_dwordx4 v[124:127], v13, s[52:55], s15 offen offset:2048
    s_waitcnt vmcnt(11)
    s_add_u32 s15, s15, 4096
    buffer_load_dwordx4 v[128:131], v13, s[52:55], s15 offen offset:0
    s_waitcnt vmcnt(11)
    buffer_load_dwordx4 v[132:135], v13, s[52:55], s15 offen offset:2048
    s_waitcnt vmcnt(11)
    s_add_u32 s15, s15, 4096
    buffer_load_dwordx4 v[136:139], v13, s[52:55], s15 offen offset:0
    s_waitcnt vmcnt(11)
    buffer_load_dwordx4 v[140:143], v13, s[52:55], s15 offen offset:2048
    s_waitcnt vmcnt(11)
    s_add_u32 s15, s15, 4096
    buffer_load_dwordx4 v[144:147], v13, s[52:55], s15 offen offset:0
    s_waitcnt vmcnt(11)
    buffer_load_dwordx4 v[148:151], v13, s[52:55], s15 offen offset:2048
    s_waitcnt vmcnt(11)
    s_add_u32 s15, s15, 4096
    buffer_load_dwordx4 v[152:155], v13, s[52:55], s15 offen offset:0
    s_waitcnt vmcnt(11)
    buffer_load_dwordx4 v[156:159], v13, s[52:55], s15 offen offset:2048
    s_waitcnt vmcnt(11)
    s_add_u32 s15, s15, 4096
    buffer_load_dwordx4 v[160:163], v13, s[52:55], s15 offen offset:0
    s_waitcnt vmcnt(11)
    buffer_load_dwordx4 v[164:167], v13, s[52:55], s15 offen offset:2048
    s_waitcnt vmcnt(11)
    s_add_u32 s15, s15, 4096
    buffer_load_dwordx4 v[168:171], v13, s[52:55], s15 offen offset:0
    s_waitcnt vmcnt(11)
    buffer_load_dwordx4 v[172:175], v13, s[52:55], s15 offen offset:2048
    s_waitcnt vmcnt(11)
    s_add_u32 s15, s15, 4096
    buffer_load_dwordx4 v[176:179], v13, s[52:55], s15 offen offset:0
    s_waitcnt vmcnt(11)
    buffer_load_dwordx4 v[180:183], v13, s[52:55], s15 offen offset:2048
    s_waitcnt vmcnt(11)
    s_add_u32 s15, s15, 4096
    buffer_load_dwordx4 v[184:187], v13, s[52:55], s15 offen offset:0
    s_waitcnt vmcnt(11)
    buffer_load_dwordx4 v[188:191], v13, s[52:55], s15 offen offset:2048
    s_waitcnt vmcnt(11)
    s_add_u32 s15, s15, 4096
    buffer_load_dwordx4 v[192:195], v13, s[52:55], s15 offen offset:0
    s_waitcnt vmcnt(11)
    buffer_load_dwordx4 v[196:199], v13, s[52:55], s15 offen offset:2048
    s_waitcnt vmcnt(11)
    s_add_u32 s15, s15, 4096
    buffer_load_dwordx4 v[200:203], v13, s[52:55], s15 offen offset:0
    s_waitcnt vmcnt(11)
    buffer_load_dwordx4 v[204:207], v13, s[52:55], s15 offen offset:2048
    s_waitcnt vmcnt(11)
    s_add_u32 s15, s15, 4096
    buffer_load_dwordx4 v[208:211], v13, s[52:55], s15 offen offset:0
    s_waitcnt vmcnt(11)
    buffer_load_dwordx4 v[212:215], v13, s[52:55], s15 offen offset:2048
    s_waitcnt vmcnt(11)
    s_add_u32 s15, s15, 4096
    buffer_load_dwordx4 v[216:219], v13, s[52:55], s15 offen offset:0
    s_waitcnt vmcnt(11)
    buffer_load_dwordx4 v[220:223], v13, s[52:55], s15 offen offset:2048
    s_mov_b64 exec, 1
    ds_add_u32 v5, v6 offset:64
    s_mov_b64 exec, -1
    v_lshlrev_b32 v8, 5, v3
    v_lshlrev_b32 v9, 4, v2
    v_xor_b32 v8, v8, v9
    v_lshl_add_u32 v8, v3, 8, v8
    s_lshl_b32 s14, s13, 14
    v_add_u32 v8, s14, v8
    v_xor_b32 v9, 128, v8
    v_lshrrev_b32 v10, 5, v1
    v_and_b32 v12, 31, v1
    v_lshlrev_b32 v12, 4, v12
    v_lshlrev_b32 v11, 5, v10
    v_xor_b32 v12, v12, v11
    v_lshl_add_u32 v12, v10, 9, v12
    s_lshl_b32 s14, s13, 15
    s_add_u32 s14, s14, 32768
    v_add_u32 v12, s14, v12
    v_xor_b32 v13, 64, v12
    v_xor_b32 v14, 128, v12
    v_xor_b32 v15, 192, v12
    s_mov_b32 s31, 0
    s_nop 0
Lw_54:
    ds_read_b32 v31, v5 offset:68
    s_waitcnt lgkmcnt(0)
    v_readfirstlane_b32 s86, v31
    s_nop 0
    s_cmp_ge_u32 s86, 4
    s_nop 2
    s_cbranch_scc1 Lwd_55
    s_sleep 1
    s_add_u32 s31, s31, 1
    s_cmp_lt_u32 s31, 1048576
    s_cbranch_scc1 Lw_54
Lwd_55:
    ds_write_b128 v8, v[32:35] offset:0
    ds_write_b128 v8, v[36:39] offset:1024
    ds_write_b128 v9, v[40:43] offset:2048
    ds_write_b128 v9, v[44:47] offset:3072
    ds_write_b128 v8, v[48:51] offset:4096
    ds_write_b128 v8, v[52:55] offset:5120
    ds_write_b128 v9, v[56:59] offset:6144
    ds_write_b128 v9, v[60:63] offset:7168
    ds_write_b128 v8, v[64:67] offset:8192
    ds_write_b128 v8, v[68:71] offset:9216
    ds_write_b128 v9, v[72:75] offset:10240
    ds_write_b128 v9, v[76:79] offset:11264
    ds_write_b128 v8, v[80:83] offset:12288
    ds_write_b128 v8, v[84:87] offset:13312
    ds_write_b128 v9, v[88:91] offset:14336
    ds_write_b128 v9, v[92:95] offset:15360
    ds_write_b128 v12, v[96:99] offset:0
    ds_write_b128 v13, v[100:103] offset:1024
    ds_write_b128 v12, v[104:107] offset:2048
    ds_write_b128 v13, v[108:111] offset:3072
    ds_write_b128 v14, v[112:115] offset:4096
    ds_write_b128 v15, v[116:119] offset:5120
    ds_write_b128 v14, v[120:123] offset:6144
    ds_write_b128 v15, v[124:127] offset:7168
    ds_write_b128 v12, v[128:131] offset:8192
    ds_write_b128 v13, v[132:135] offset:9216
    ds_write_b128 v12, v[136:139] offset:10240
    ds_write_b128 v13, v[140:143] offset:11264
    ds_write_b128 v14, v[144:147] offset:12288
    ds_write_b128 v15, v[148:151] offset:13312
    ds_write_b128 v14, v[152:155] offset:14336
    ds_write_b128 v15, v[156:159] offset:15360
    ds_write_b128 v12, v[160:163] offset:16384
    ds_write_b128 v13, v[164:167] offset:17408
    ds_write_b128 v12, v[168:171] offset:18432
    ds_write_b128 v13, v[172:175] offset:19456
    s_waitcnt vmcnt(11)
    ds_write_b128 v14, v[176:179] offset:20480
    s_waitcnt vmcnt(10)
    ds_write_b128 v15, v[180:183] offset:21504
    s_waitcnt vmcnt(9)
    ds_write_b128 v14, v[184:187] offset:22528
    s_waitcnt vmcnt(8)
    ds_write_b128 v15, v[188:191] offset:23552
    s_waitcnt vmcnt(7)
    ds_write_b128 v12, v[192:195] offset:24576
    s_waitcnt vmcnt(6)
    ds_write_b128 v13, v[196:199] offset:25600
    s_waitcnt vmcnt(5)
    ds_write_b128 v12, v[200:203] offset:26624
    s_waitcnt vmcnt(4)
    ds_write_b128 v13, v[204:207] offset:27648
    s_waitcnt vmcnt(3)
    ds_write_b128 v14, v[208:211] offset:28672
    s_waitcnt vmcnt(2)
    ds_write_b128 v15, v[212:215] offset:29696
    s_waitcnt vmcnt(1)
    ds_write_b128 v14, v[216:219] offset:30720
    s_waitcnt vmcnt(0)
    ds_write_b128 v15, v[220:223] offset:31744
    s_mov_b64 exec, 1
    ds_add_u32 v5, v6 offset:72
    s_mov_b64 exec, -1
L_phaseC:
    v_bfe_u32 v20, v1, 2, 2
    v_and_b32 v21, 1, v3
    v_lshl_add_u32 v21, v21, 2, v20
    v_lshl_add_u32 v20, v3, 3, v20
    v_and_b32 v22, 3, v1
    v_lshlrev_b32 v22, 3, v22
    s_lshl_b32 s13, s92, 1
    v_xor_b32 v12, s13, v21
    v_lshl_add_u32 v12, v12, 5, v22
    v_lshl_add_u32 v12, v20, 8, v12
    s_lshl_b32 s13, s92, 2
    v_xor_b32 v13, s13, v21
    v_lshl_add_u32 v13, v13, 5, v22
    v_lshl_add_u32 v13, v20, 9, v13
    v_add_u32 v13, 32768, v13
    v_and_b32 v20, 3, v2
    v_mul_u32_u24 v20, 272, v20
    v_lshl_add_u32 v16, v3, 4, v20
    v_add_u32 v14, 157248, v16
    v_add_u32 v16, 159488, v16
    v_lshl_add_u32 v15, v3, 3, v20
    s_lshl_b32 s13, s92, 6
    s_add_u32 s13, s13, 159488
    v_add_u32 v15, s13, v15
    v_lshlrev_b32 v17, 4, v3
    v_and_b32 v20, 3, v2
    v_lshl_add_u32 v17, v20, 17, v17
    v_lshrrev_b32 v20, 2, v2
    v_lshl_add_u32 v17, v20, 6, v17
    s_lshl_b32 s14, s9, 2
    s_add_u32 s14, s14, s92
    s_lshl_b32 s14, s14, 14
    s_lshl_b32 s15, s6, 2
    s_add_u32 s15, s15, s8
    s_lshl_b32 s15, s15, 7
    s_add_u32 s14, s14, s15
    s_add_u32 s14, s14, 524288
    s_mov_b32 s31, 0
Lw_56:
    ds_read_b32 v31, v5 offset:72
    s_waitcnt lgkmcnt(0)
    v_readfirstlane_b32 s86, v31
    s_nop 0
    s_cmp_ge_u32 s86, 2
    s_nop 2
    s_cbranch_scc1 Lwd_57
    s_sleep 1
    s_add_u32 s31, s31, 1
    s_cmp_lt_u32 s31, 1048576
    s_cbranch_scc1 Lw_56
Lwd_57:
    ds_read_b64_tr_b16 v[32:33], v12 offset:0
    ds_read_b64_tr_b16 v[34:35], v12 offset:1024
    ds_read_b64_tr_b16 v[36:37], v12 offset:8192
    ds_read_b64_tr_b16 v[38:39], v12 offset:9216
    ds_read_b64_tr_b16 v[40:41], v12 offset:16384
    ds_read_b64_tr_b16 v[42:43], v12 offset:17408
    ds_read_b64_tr_b16 v[44:45], v12 offset:24576
    ds_read_b64_tr_b16 v[46:47], v12 offset:25600
    v_xor_b32 v20, 32, v12
    ds_read_b64_tr_b16 v[48:49], v20 offset:0
    ds_read_b64_tr_b16 v[50:51], v20 offset:1024
    ds_read_b64_tr_b16 v[52:53], v20 offset:8192
    ds_read_b64_tr_b16 v[54:55], v20 offset:9216
    ds_read_b64_tr_b16 v[56:57], v20 offset:16384
    ds_read_b64_tr_b16 v[58:59], v20 offset:17408
    ds_read_b64_tr_b16 v[60:61], v20 offset:24576
    ds_read_b64_tr_b16 v[62:63], v20 offset:25600
    ds_read_b64_tr_b16 v[64:65], v13 offset:0
    ds_read_b64_tr_b16 v[66:67], v13 offset:2048
    ds_read_b64_tr_b16 v[68:69], v13 offset:16384
    ds_read_b64_tr_b16 v[70:71], v13 offset:18432
    ds_read_b64_tr_b16 v[72:73], v13 offset:32768
    ds_read_b64_tr_b16 v[74:75], v13 offset:34816
    ds_read_b64_tr_b16 v[76:77], v13 offset:49152
    ds_read_b64_tr_b16 v[78:79], v13 offset:51200
    v_xor_b32 v20, 32, v13
    ds_read_b64_tr_b16 v[80:81], v20 offset:0
    ds_read_b64_tr_b16 v[82:83], v20 offset:2048
    ds_read_b64_tr_b16 v[84:85], v20 offset:16384
    ds_read_b64_tr_b16 v[86:87], v20 offset:18432
    ds_read_b64_tr_b16 v[88:89], v20 offset:32768
    ds_read_b64_tr_b16 v[90:91], v20 offset:34816
    ds_read_b64_tr_b16 v[92:93], v20 offset:49152
    ds_read_b64_tr_b16 v[94:95], v20 offset:51200
    v_xor_b32 v20, 64, v13
    ds_read_b64_tr_b16 v[96:97], v20 offset:0
    ds_read_b64_tr_b16 v[98:99], v20 offset:2048
    ds_read_b64_tr_b16 v[100:101], v20 offset:16384
    ds_read_b64_tr_b16 v[102:103], v20 offset:18432
    ds_read_b64_tr_b16 v[104:105], v20 offset:32768
    ds_read_b64_tr_b16 v[106:107], v20 offset:34816
    ds_read_b64_tr_b16 v[108:109], v20 offset:49152
    ds_read_b64_tr_b16 v[110:111], v20 offset:51200
    v_xor_b32 v20, 96, v13
    ds_read_b64_tr_b16 v[112:113], v20 offset:0
    ds_read_b64_tr_b16 v[114:115], v20 offset:2048
    ds_read_b64_tr_b16 v[116:117], v20 offset:16384
    ds_read_b64_tr_b16 v[118:119], v20 offset:18432
    ds_read_b64_tr_b16 v[120:121], v20 offset:32768
    ds_read_b64_tr_b16 v[122:123], v20 offset:34816
    ds_read_b64_tr_b16 v[124:125], v20 offset:49152
    ds_read_b64_tr_b16 v[126:127], v20 offset:51200
    s_setprio 2
    s_mov_b32 s31, 0
Lw_58:
    ds_read_b32 v31, v5 offset:76
    ds_read_b128 v[128:131], v14 offset:0
    ds_read_b128 v[132:135], v14 offset:64
    ds_read_b128 v[136:139], v14 offset:128
    ds_read_b128 v[140:143], v14 offset:192
    s_waitcnt lgkmcnt(0)
    v_readfirstlane_b32 s86, v31
    s_nop 0
    s_cmp_ge_u32 s86, 4
    s_nop 2
    s_cbranch_scc1 Lwd_59
    s_add_u32 s31, s31, 1
    s_cmp_lt_u32 s31, 1048576
    s_cbranch_scc1 Lw_58
Lwd_59:
    s_cmp_ge_u32 s3, 6
    s_cbranch_scc1 L_nopf2
    buffer_load_dword v30, v9, s[64:67], s23 offen
    s_cmp_eq_u32 s3, 5
    s_cbranch_scc1 L_w5upb
    buffer_load_dword v29, v8, s[56:59], s22 offen
    s_branch L_pfdb
L_w5upb:
    buffer_load_dword v29, v8, s[60:63], s22 offen
L_pfdb:
L_nopf2:
    v_mfma_f32_16x16x32_bf16 v[144:147], v[32:35], v[128:131], 0
    v_mfma_f32_16x16x32_bf16 v[148:151], v[48:51], v[128:131], 0
    v_mfma_f32_16x16x32_bf16 v[144:147], v[36:39], v[132:135], v[144:147]
    v_mfma_f32_16x16x32_bf16 v[148:151], v[52:55], v[132:135], v[148:151]
    v_mfma_f32_16x16x32_bf16 v[144:147], v[40:43], v[136:139], v[144:147]
    v_mfma_f32_16x16x32_bf16 v[148:151], v[56:59], v[136:139], v[148:151]
    v_mfma_f32_16x16x32_bf16 v[144:147], v[44:47], v[140:143], v[144:147]
    v_mfma_f32_16x16x32_bf16 v[148:151], v[60:63], v[140:143], v[148:151]
    s_nop 6
    v_cvt_pk_bf16_f32 v152, v144, v145
    v_cvt_pk_bf16_f32 v153, v146, v147
    v_cvt_pk_bf16_f32 v154, v148, v149
    v_cvt_pk_bf16_f32 v155, v150, v151
    s_mov_b64 exec, s[84:85]
    ds_write_b64 v15, v[152:153]
    ds_write_b64 v15, v[154:155] offset:32
    s_mov_b64 exec, 1
    ds_add_u32 v5, v6 offset:80
    s_mov_b64 exec, -1
    s_mov_b32 s31, 0
Lw_60:
    ds_read_b32 v31, v5 offset:80
    ds_read_b128 v[128:131], v16 offset:0
    ds_read_b128 v[132:135], v16 offset:64
    ds_read_b128 v[136:139], v16 offset:128
    ds_read_b128 v[140:143], v16 offset:192
    s_waitcnt lgkmcnt(0)
    v_readfirstlane_b32 s86, v31
    s_nop 0
    s_cmp_ge_u32 s86, 4
    s_nop 2
    s_cbranch_scc1 Lwd_61
    s_add_u32 s31, s31, 1
    s_cmp_lt_u32 s31, 1048576
    s_cbranch_scc1 Lw_60
Lwd_61:
    v_mfma_f32_16x16x32_bf16 v[160:163], v[64:67], v[128:131], 0
    v_mfma_f32_16x16x32_bf16 v[164:167], v[80:83], v[128:131], 0
    v_mfma_f32_16x16x32_bf16 v[160:163], v[68:71], v[132:135], v[160:163]
    v_mfma_f32_16x16x32_bf16 v[164:167], v[84:87], v[132:135], v[164:167]
    v_mfma_f32_16x16x32_bf16 v[160:163], v[72:75], v[136:139], v[160:163]
    v_mfma_f32_16x16x32_bf16 v[164:167], v[88:91], v[136:139], v[164:167]
    v_mfma_f32_16x16x32_bf16 v[160:163], v[76:79], v[140:143], v[160:163]
    v_mfma_f32_16x16x32_bf16 v[164:167], v[92:95], v[140:143], v[164:167]
    v_mfma_f32_16x16x32_bf16 v[168:171], v[96:99], v[128:131], 0
    v_mfma_f32_16x16x32_bf16 v[172:175], v[112:115], v[128:131], 0
    v_mfma_f32_16x16x32_bf16 v[168:171], v[100:103], v[132:135], v[168:171]
    v_mfma_f32_16x16x32_bf16 v[172:175], v[116:119], v[132:135], v[172:175]
    v_mfma_f32_16x16x32_bf16 v[168:171], v[104:107], v[136:139], v[168:171]
    v_mfma_f32_16x16x32_bf16 v[172:175], v[120:123], v[136:139], v[172:175]
    v_mfma_f32_16x16x32_bf16 v[168:171], v[108:111], v[140:143], v[168:171]
    v_mfma_f32_16x16x32_bf16 v[172:175], v[124:127], v[140:143], v[172:175]
    v_cvt_pk_bf16_f32 v176, v160, v161
    v_cvt_pk_bf16_f32 v177, v162, v163
    v_cvt_pk_bf16_f32 v178, v164, v165
    v_cvt_pk_bf16_f32 v179, v166, v167
    s_lshl_b64 exec, s[84:85], 4
    s_nop 1
    v_cvt_pk_bf16_f32 v176, v168, v169
    v_cvt_pk_bf16_f32 v177, v170, v171
    v_cvt_pk_bf16_f32 v178, v172, v173
    v_cvt_pk_bf16_f32 v179, v174, v175
    s_mov_b64 exec, s[82:83]
    buffer_store_dwordx4 v[176:179], v17, s[72:75], s14 offen sc1
    s_mov_b64 exec, -1
    s_waitcnt vmcnt(0)
L_fin:
L_end:

    s_endpgm
.section .rodata,"a"
.p2align 6
.amdhsa_kernel sequential_preLN__compressed_kv_cla__swiglu_ffn__decode_kernel
  .amdhsa_next_free_vgpr 256
  .amdhsa_next_free_sgpr 102
  .amdhsa_accum_offset 256
  .amdhsa_group_segment_fixed_size 0
  .amdhsa_kernarg_size 104
  .amdhsa_user_sgpr_count 2
  .amdhsa_user_sgpr_kernarg_segment_ptr 1
  .amdhsa_system_sgpr_workgroup_id_x 1
.end_amdhsa_kernel
```
